```python
import torch

def _softmax(x, axis=-1):
    return torch.softmax(x, dim=axis)
def _gelu(x):
    return torch.nn.functional.gelu(x, approximate="tanh")
def _silu(x):
    return torch.nn.functional.silu(x)
def _sigmoid(x):
    return torch.sigmoid(x)
def _layernorm(x, axis=-1, eps=1e-5):
    m = x.mean(dim=axis, keepdim=True)
    v = x.var(dim=axis, keepdim=True, unbiased=False)
    return (x - m) / torch.sqrt(v + eps)
def _scatter_add(tgt, idx, src, axis=0):
    return tgt.clone().index_add_(axis, idx, src)
def _segment_sum(src, seg, n):
    out = torch.zeros((n,) + src.shape[1:], dtype=src.dtype)
    return out.index_add_(0, seg, src)
def _pad(x, pw):
    flat = tuple(v for pair in reversed(pw) for v in pair)
    return torch.nn.functional.pad(x, flat)

kernel_name = 'concat_heads__gqa_block_cached__gqa_block_cached__near_ridge'

def setup_inputs():

    _w = (lambda a: (lambda t: t.to(torch.bfloat16) if t.is_floating_point() else t)(torch.as_tensor(a)))
    def _A_setup():
        B, Sq, D = 8, 128, 640
        Hq, Hkv, Sk, Dh = 32, 32, 512, 192
        assert Hq % Hkv == 0, (Hq, Hkv)
        return {
            "x": _w((lambda *s: torch.randn(*s, dtype=torch.bfloat16) * 0.8)(B, Sq, D)),
            "k_cache": _w((lambda *s: torch.randn(*s, dtype=torch.bfloat16) * 0.8)(B, Hkv, Sk, Dh)),
            "v_cache": _w((lambda *s: torch.randn(*s, dtype=torch.bfloat16) * 0.05)(B, Hkv, Sk, Dh)),
            "wq": _w((lambda *s: torch.randn(*s, dtype=torch.bfloat16) * 0.8)(D, Hq * Dh) * (D ** -0.5)),
            "wo": _w((lambda *s: torch.randn(*s, dtype=torch.bfloat16) * 0.05)(Hq * Dh, D) * ((Hq * Dh) ** -0.5)),
        }
    _A_in = _A_setup()

    def _B_setup():
        B, Sq, D = 8, 128, 640
        Hq, Hkv, Sk, Dh = 32, 32, 512, 192
        assert Hq % Hkv == 0, (Hq, Hkv)
        return {
            "x": _w((lambda *s: torch.randn(*s, dtype=torch.bfloat16) * 0.8)(B, Sq, D)),
            "k_cache": _w((lambda *s: torch.randn(*s, dtype=torch.bfloat16) * 0.8)(B, Hkv, Sk, Dh)),
            "v_cache": _w((lambda *s: torch.randn(*s, dtype=torch.bfloat16) * 0.05)(B, Hkv, Sk, Dh)),
            "wq": _w((lambda *s: torch.randn(*s, dtype=torch.bfloat16) * 0.8)(D, Hq * Dh) * (D ** -0.5)),
            "wo": _w((lambda *s: torch.randn(*s, dtype=torch.bfloat16) * 0.05)(Hq * Dh, D) * ((Hq * Dh) ** -0.5)),
        }
    _B_in = _B_setup()

    return {
        "A_x": _A_in["x"],
        "A_k_cache": _A_in["k_cache"],
        "A_v_cache": _A_in["v_cache"],
        "A_wq": _A_in["wq"],
        "A_wo": _A_in["wo"],
        "B_x": _B_in["x"],
        "B_k_cache": _B_in["k_cache"],
        "B_v_cache": _B_in["v_cache"],
        "B_wq": _B_in["wq"],
        "B_wo": _B_in["wo"],
    }

def reference(A_x, A_k_cache, A_v_cache, A_wq, A_wo, B_x, B_k_cache, B_v_cache, B_wq, B_wo):
    def _A_ref(x, k_cache, v_cache, wq, wo):
        B, Sq, D = x.shape
        Hq, Dh = 32, 192
        Hkv = k_cache.shape[1]
        rep = Hq // Hkv
        q = (lambda x, *d: x.permute(*d))((x @ wq).reshape(B, Sq, Hq, Dh), 0, 2, 1, 3)
        k = (lambda x, n, axis: torch.repeat_interleave(x, n, dim=axis))(k_cache, rep, axis=1)
        v = (lambda x, n, axis: torch.repeat_interleave(x, n, dim=axis))(v_cache, rep, axis=1)
        scores = torch.einsum("bhqd,bhkd->bhqk", q, k) * (Dh ** -0.5)
        p = _softmax(scores, axis=-1)
        o = torch.einsum("bhqk,bhkd->bhqd", p, v)
        return (lambda x, *d: x.permute(*d))(o, 0, 2, 1, 3).reshape(B, Sq, Hq * Dh) @ wo

    def _B_ref(x, k_cache, v_cache, wq, wo):
        B, Sq, D = x.shape
        Hq, Dh = 32, 192
        Hkv = k_cache.shape[1]
        rep = Hq // Hkv
        q = (lambda x, *d: x.permute(*d))((x @ wq).reshape(B, Sq, Hq, Dh), 0, 2, 1, 3)
        k = (lambda x, n, axis: torch.repeat_interleave(x, n, dim=axis))(k_cache, rep, axis=1)
        v = (lambda x, n, axis: torch.repeat_interleave(x, n, dim=axis))(v_cache, rep, axis=1)
        scores = torch.einsum("bhqd,bhkd->bhqk", q, k) * (Dh ** -0.5)
        p = _softmax(scores, axis=-1)
        o = torch.einsum("bhqk,bhkd->bhqd", p, v)
        return (lambda x, *d: x.permute(*d))(o, 0, 2, 1, 3).reshape(B, Sq, Hq * Dh) @ wo

    a = _A_ref(A_x, A_k_cache, A_v_cache, A_wq, A_wo)
    b = _B_ref(B_x, B_k_cache, B_v_cache, B_wq, B_wo)
    return torch.concatenate([a, b], axis=-1)
```

```asm
; @launch kernel=attn_kernel grid=(256,1,1) block=(512,1,1) lds=155648
; @launch kernel=reduce_kernel grid=(256,1,1) block=(640,1,1) lds=0
.amdgcn_target "amdgcn-amd-amdhsa--gfx950"
.text
.globl attn_kernel
.p2align 8
.type attn_kernel,@function
attn_kernel:
    s_cmp_ge_u32 s2, 256
    s_cbranch_scc1 L_end
    s_load_dwordx16 s[48:63], s[0:1], 0
    s_load_dwordx8 s[64:71], s[0:1], 64
    s_load_dwordx2 s[72:73], s[0:1], 96
    v_lshrrev_b32 v3, 6, v0
    v_and_b32 v1, 63, v0
    v_readfirstlane_b32 s35, v3
    v_lshrrev_b32 v2, 5, v1
    s_bfe_u32 s76, s2, 0x10002
    s_bfe_u32 s77, s2, 0x30005
    s_and_b32 s78, s2, 3
    s_lshl_b32 s78, s78, 2
    s_bfe_u32 s43, s2, 0x20003
    s_add_u32 s78, s78, s43
    s_lshr_b32 s36, s35, 2
    s_and_b32 s37, s35, 3
    s_lshl_b32 s79, s78, 1
    s_add_u32 s79, s79, s36
    s_mul_i32 s34, s35, 3072
    s_lshl_b32 s45, s35, 11
    s_add_u32 s45, s45, 122880
    s_mov_b32 s42, 0x3dd53b95
    s_mov_b32 s44, 0x41000000
    s_mul_i32 s43, s37, 24
    v_lshrrev_b32 v3, 3, v1
    v_add_u32 v3, s43, v3
    v_mul_u32_u24 v4, 43, v3
    v_lshrrev_b32 v4, 7, v4
    v_bfe_u32 v5, v4, 2, 2
    v_bfe_u32 v6, v4, 1, 1
    v_lshl_or_b32 v5, v6, 2, v5
    v_and_b32 v6, 7, v1
    v_xor_b32 v5, v5, v6
    v_lshlrev_b32 v5, 4, v5
    v_lshl_add_u32 v16, v3, 7, v5
    v_mul_u32_u24 v4, 11904, v4
    v_add_u32 v20, v16, v4
    v_lshrrev_b32 v3, 3, v1
    v_add_u32 v3, s43, v3
    v_add_u32 v3, 8, v3
    v_mul_u32_u24 v4, 43, v3
    v_lshrrev_b32 v4, 7, v4
    v_bfe_u32 v5, v4, 2, 2
    v_bfe_u32 v6, v4, 1, 1
    v_lshl_or_b32 v5, v6, 2, v5
    v_and_b32 v6, 7, v1
    v_xor_b32 v5, v5, v6
    v_lshlrev_b32 v5, 4, v5
    v_lshl_add_u32 v17, v3, 7, v5
    v_subrev_u32 v17, 1024, v17
    v_mul_u32_u24 v4, 11904, v4
    v_add_u32 v21, v17, v4
    v_lshrrev_b32 v3, 3, v1
    v_add_u32 v3, s43, v3
    v_add_u32 v3, 16, v3
    v_mul_u32_u24 v4, 43, v3
    v_lshrrev_b32 v4, 7, v4
    v_bfe_u32 v5, v4, 2, 2
    v_bfe_u32 v6, v4, 1, 1
    v_lshl_or_b32 v5, v6, 2, v5
    v_and_b32 v6, 7, v1
    v_xor_b32 v5, v5, v6
    v_lshlrev_b32 v5, 4, v5
    v_lshl_add_u32 v18, v3, 7, v5
    v_subrev_u32 v18, 2048, v18
    v_mul_u32_u24 v4, 11904, v4
    v_add_u32 v22, v18, v4
    v_lshrrev_b32 v3, 4, v1
    v_lshlrev_b32 v4, 2, v3
    v_and_b32 v5, 15, v1
    v_xor_b32 v4, v4, v5
    v_lshlrev_b32 v4, 4, v4
    s_mul_i32 s43, s35, 12
    v_add_u32 v3, s43, v3
    v_mul_u32_u24 v3, 1280, v3
    v_add_u32 v24, v3, v4
    v_add_u32 v25, 4096, v24
    v_add_u32 v26, 8192, v24
    v_lshrrev_b32 v3, 4, v1
    v_and_b32 v4, 7, v1
    v_xor_b32 v4, v4, v3
    v_lshlrev_b32 v4, 4, v4
    s_lshl_b32 s43, s35, 4
    v_lshrrev_b32 v3, 3, v1
    v_add_u32 v3, s43, v3
    v_mul_u32_u24 v3, 1280, v3
    v_add_u32 v28, v3, v4
    v_lshrrev_b32 v3, 4, v1
    v_add_u32 v3, 4, v3
    v_and_b32 v4, 7, v1
    v_xor_b32 v4, v4, v3
    v_lshlrev_b32 v4, 4, v4
    s_lshl_b32 s43, s35, 4
    v_lshrrev_b32 v3, 3, v1
    v_add_u32 v3, s43, v3
    v_mul_u32_u24 v3, 1280, v3
    v_add_u32 v29, v3, v4
    v_add_u32 v29, 9216, v29
    s_waitcnt lgkmcnt(0)
    s_cmp_eq_u32 s76, 0
    s_cselect_b64 s[48:49], s[48:49], s[58:59]
    s_cselect_b64 s[50:51], s[50:51], s[60:61]
    s_cselect_b64 s[52:53], s[52:53], s[62:63]
    s_cselect_b64 s[54:55], s[54:55], s[64:65]
    s_cselect_b64 s[56:57], s[56:57], s[66:67]
    s_mul_i32 s43, s77, 163840
    s_add_u32 s24, s48, s43
    s_addc_u32 s25, s49, 0
    s_and_b32 s25, s25, 0xffff
    s_mov_b32 s26, 163840
    s_mov_b32 s27, 0x20000
    s_mul_i32 s43, s79, 384
    s_sub_u32 s38, 7864320, s43
    s_add_u32 s16, s54, s43
    s_addc_u32 s17, s55, 0
    s_and_b32 s17, s17, 0xffff
    s_mov_b32 s18, s38
    s_mov_b32 s19, 0x20000
    s_mov_b32 s39, 0
    s_mov_b32 s41, 0
    s_mov_b32 s40, 0
    s_mov_b32 s74, 0
    s_mov_b32 s75, 0
    s_mov_b32 s33, 0
    s_add_u32 m0, s45, 0
    s_nop 0
    buffer_load_dwordx4 v28, s[24:27], s41 offen lds
    buffer_load_dwordx4 v29, s[24:27], s41 offen offset:1024 lds
    s_add_u32 s41, s41, 128
    s_add_u32 m0, s33, s34
    s_nop 0
    buffer_load_dwordx4 v20, s[16:19], s39 offen offset:0  lds
    buffer_load_dwordx4 v21, s[16:19], s39 offen offset:1024  lds
    buffer_load_dwordx4 v22, s[16:19], s39 offen offset:2048  lds
    s_add_u32 s39, s39, 393216
    s_mov_b32 s33, 24576
    s_add_u32 m0, s45, 16384
    s_nop 0
    buffer_load_dwordx4 v28, s[24:27], s41 offen lds
    buffer_load_dwordx4 v29, s[24:27], s41 offen offset:1024 lds
    s_add_u32 s41, s41, 128
    s_add_u32 m0, s33, s34
    s_nop 0
    buffer_load_dwordx4 v20, s[16:19], s39 offen offset:0  lds
    buffer_load_dwordx4 v21, s[16:19], s39 offen offset:1024  lds
    buffer_load_dwordx4 v22, s[16:19], s39 offen offset:2048  lds
    s_add_u32 s39, s39, 393216
    s_mov_b32 s33, 49152
    s_add_u32 m0, s33, s34
    s_nop 0
    buffer_load_dwordx4 v20, s[16:19], s39 offen offset:0  lds
    buffer_load_dwordx4 v21, s[16:19], s39 offen offset:1024  lds
    buffer_load_dwordx4 v22, s[16:19], s39 offen offset:2048  lds
    s_add_u32 s39, s39, 393216
    s_mov_b32 s33, 73728
    s_add_u32 m0, s33, s34
    s_nop 0
    buffer_load_dwordx4 v20, s[16:19], s39 offen offset:0  lds
    buffer_load_dwordx4 v21, s[16:19], s39 offen offset:1024  lds
    buffer_load_dwordx4 v22, s[16:19], s39 offen offset:2048  lds
    s_add_u32 s39, s39, 393216
    s_mov_b32 s33, 98304
    s_add_u32 m0, s33, s34
    s_nop 0
    buffer_load_dwordx4 v20, s[16:19], s39 offen offset:0  lds
    buffer_load_dwordx4 v21, s[16:19], s39 offen offset:1024  lds
    buffer_load_dwordx4 v22, s[16:19], s39 offen offset:2048  lds
    s_add_u32 s39, s39, 393216
    v_mul_u32_u24 v3, 171, v0
    v_lshrrev_b32 v3, 10, v3
    v_mul_u32_u24 v4, 11520, v3
    v_lshlrev_b32 v47, 7, v0
    v_add_u32 v19, v4, v47
    s_mul_i32 s43, s78, 768
    s_mul_i32 s38, s77, 245760
    s_add_u32 s43, s43, s38
    s_add_u32 s43, s43, 1966080
    s_add_u32 s20, s54, s43
    s_addc_u32 s21, s55, 0
    s_and_b32 s21, s21, 0xffff
    s_mov_b32 s22, 234240
    s_mov_b32 s23, 0x20000
    buffer_load_dword v46, v19, s[20:23], 0 offen
    s_add_u32 s43, s43, s38
    s_add_u32 s43, s43, 1966080
    s_add_u32 s4, s54, s43
    s_addc_u32 s5, s55, 0
    s_and_b32 s5, s5, 0xffff
    s_mov_b32 s6, 480000
    s_mov_b32 s7, 0x20000
    s_mov_b32 s32, 0
    s_lshl_b32 s43, s77, 1
    s_add_u32 s43, s43, s79
    s_add_u32 s43, s43, s76
    s_and_b32 s43, s43, 15
    s_mul_i32 s40, s43, 12288
    s_mov_b32 s74, s40
    s_lshl_b32 s43, s77, 5
    s_add_u32 s43, s43, s79
    s_mul_i32 s43, s43, 196608
    s_add_u32 s8, s50, s43
    s_addc_u32 s9, s51, 0
    s_and_b32 s9, s9, 0xffff
    s_mov_b32 s10, 196608
    s_mov_b32 s11, 0x20000
    s_add_u32 s12, s52, s43
    s_addc_u32 s13, s53, 0
    s_and_b32 s13, s13, 0xffff
    s_mov_b32 s14, 196608
    s_mov_b32 s15, 0x20000
    s_mul_i32 s43, s78, 491520
    s_add_u32 s20, s56, s43
    s_addc_u32 s21, s57, 0
    s_and_b32 s21, s21, 0xffff
    s_mov_b32 s22, 491520
    s_mov_b32 s23, 0x20000
    s_lshl_b32 s43, s76, 3
    s_add_u32 s43, s43, s77
    s_lshl_b32 s43, s43, 4
    s_add_u32 s43, s43, s78
    s_mul_i32 s43, s43, 163840
    s_mul_i32 s38, s37, 40960
    s_add_u32 s43, s43, s38
    s_add_u32 s28, s72, s43
    s_addc_u32 s29, s73, 0
    s_and_b32 s29, s29, 0xffff
    s_mov_b32 s30, 40960
    s_mov_b32 s31, 0x20000
    s_lshl_b32 s46, s36, 12
    v_lshlrev_b32 v43, 4, v1
    s_mul_i32 s43, s36, 12288
    v_and_b32 v3, 0x13, v1
    v_bfe_u32 v4, v1, 2, 1
    v_lshl_or_b32 v3, v4, 3, v3
    v_bfe_u32 v4, v1, 3, 1
    v_lshl_or_b32 v3, v4, 2, v3
    v_bfe_u32 v4, v3, 2, 2
    v_bfe_u32 v5, v3, 1, 1
    v_lshl_or_b32 v4, v5, 2, v4
    v_xor_b32 v4, v4, v2
    v_lshlrev_b32 v4, 4, v4
    v_mul_u32_u24 v3, 384, v3
    v_add3_u32 v8, v3, v4, s43
    s_and_b32 s38, s37, 1
    s_lshl_b32 s38, s38, 6
    v_xor_b32 v8, s38, v8
    v_bfe_u32 v3, v1, 2, 2
    v_lshl_add_u32 v3, v2, 3, v3
    v_mul_u32_u24 v3, 384, v3
    v_bfe_u32 v4, v1, 3, 1
    v_lshl_add_u32 v3, v4, 6, v3
    v_bfe_u32 v4, v1, 4, 1
    v_xor_b32 v4, v4, v2
    v_lshl_add_u32 v3, v4, 5, v3
    v_and_b32 v4, 1, v1
    v_lshl_add_u32 v3, v4, 4, v3
    v_bfe_u32 v4, v1, 1, 1
    v_lshl_add_u32 v3, v4, 3, v3
    v_add_u32 v9, s43, v3
    v_xor_b32 v76, s38, v9
    v_bfe_u32 v3, v1, 2, 2
    v_lshlrev_b32 v5, 2, v3
    v_lshl_add_u32 v3, v2, 3, v3
    v_lshlrev_b32 v3, 8, v3
    v_bfe_u32 v4, v1, 4, 1
    v_lshlrev_b32 v4, 1, v4
    v_and_b32 v6, 1, v1
    v_or_b32 v4, v4, v6
    s_lshl_b32 s43, s36, 3
    v_or_b32 v4, s43, v4
    v_xor_b32 v4, v4, v5
    v_lshl_add_u32 v3, v4, 4, v3
    v_bfe_u32 v4, v1, 1, 1
    v_lshl_add_u32 v10, v4, 3, v3
    v_and_b32 v3, 31, v1
    v_bfe_u32 v4, v1, 1, 3
    v_xor_b32 v4, v4, v2
    v_lshlrev_b32 v4, 4, v4
    v_lshl_add_u32 v3, v3, 7, v4
    s_lshl_b32 s43, s37, 12
    s_add_u32 s43, s43, 122880
    v_add_u32 v32, s43, v3
    v_xor_b32 v33, 32, v32
    v_xor_b32 v34, 64, v32
    v_xor_b32 v35, 96, v32
    v_xor_b32 v72, 0x1000, v32
    v_xor_b32 v73, 0x1000, v33
    v_xor_b32 v74, 0x1000, v34
    v_xor_b32 v75, 0x1000, v35
    s_mul_i32 s38, s35, 6144
    s_add_u32 s38, s38, 106496
    v_add_u32 v77, s38, v43
    s_xor_b32 s38, s35, 1
    s_mul_i32 s38, s38, 6144
    s_add_u32 s38, s38, 106496
    v_add_u32 v78, s38, v43
    v_add_u32 v45, s43, v43
    s_lshl_b32 s43, s35, 12
    s_add_u32 s43, s43, 122880
    v_add_u32 v44, s43, v43
    v_mov_b32 v160, 0
    v_mov_b32 v161, 0
    v_mov_b32 v162, 0
    v_mov_b32 v163, 0
    v_mov_b32 v164, 0
    v_mov_b32 v165, 0
    v_mov_b32 v166, 0
    v_mov_b32 v167, 0
    v_mov_b32 v168, 0
    v_mov_b32 v169, 0
    v_mov_b32 v170, 0
    v_mov_b32 v171, 0
    v_mov_b32 v172, 0
    v_mov_b32 v173, 0
    v_mov_b32 v174, 0
    v_mov_b32 v175, 0
    v_mov_b32 v176, 0
    v_mov_b32 v177, 0
    v_mov_b32 v178, 0
    v_mov_b32 v179, 0
    v_mov_b32 v180, 0
    v_mov_b32 v181, 0
    v_mov_b32 v182, 0
    v_mov_b32 v183, 0
    v_mov_b32 v184, 0
    v_mov_b32 v185, 0
    v_mov_b32 v186, 0
    v_mov_b32 v187, 0
    v_mov_b32 v188, 0
    v_mov_b32 v189, 0
    v_mov_b32 v190, 0
    v_mov_b32 v191, 0
    v_mov_b32 v192, 0
    v_mov_b32 v193, 0
    v_mov_b32 v194, 0
    v_mov_b32 v195, 0
    v_mov_b32 v196, 0
    v_mov_b32 v197, 0
    v_mov_b32 v198, 0
    v_mov_b32 v199, 0
    v_mov_b32 v200, 0
    v_mov_b32 v201, 0
    v_mov_b32 v202, 0
    v_mov_b32 v203, 0
    v_mov_b32 v204, 0
    v_mov_b32 v205, 0
    v_mov_b32 v206, 0
    v_mov_b32 v207, 0
    v_mov_b32 v208, 0
    v_mov_b32 v209, 0
    v_mov_b32 v210, 0
    v_mov_b32 v211, 0
    v_mov_b32 v212, 0
    v_mov_b32 v213, 0
    v_mov_b32 v214, 0
    v_mov_b32 v215, 0
    v_mov_b32 v216, 0
    v_mov_b32 v217, 0
    v_mov_b32 v218, 0
    v_mov_b32 v219, 0
    v_mov_b32 v220, 0
    v_mov_b32 v221, 0
    v_mov_b32 v222, 0
    v_mov_b32 v223, 0
    v_mov_b32 v224, 0
    v_mov_b32 v225, 0
    v_mov_b32 v226, 0
    v_mov_b32 v227, 0
    v_mov_b32 v228, 0
    v_mov_b32 v229, 0
    v_mov_b32 v230, 0
    v_mov_b32 v231, 0
    v_mov_b32 v232, 0
    v_mov_b32 v233, 0
    v_mov_b32 v234, 0
    v_mov_b32 v235, 0
    v_mov_b32 v236, 0
    v_mov_b32 v237, 0
    v_mov_b32 v238, 0
    v_mov_b32 v239, 0
    v_mov_b32 v240, 0
    v_mov_b32 v241, 0
    v_mov_b32 v242, 0
    v_mov_b32 v243, 0
    v_mov_b32 v244, 0
    v_mov_b32 v245, 0
    v_mov_b32 v246, 0
    v_mov_b32 v247, 0
    v_mov_b32 v248, 0
    v_mov_b32 v249, 0
    v_mov_b32 v250, 0
    v_mov_b32 v251, 0
    v_mov_b32 v252, 0
    v_mov_b32 v253, 0
    v_mov_b32 v254, 0
    v_mov_b32 v255, 0
    v_mov_b32 v36, 0xf149f2ca
    v_mov_b32 v37, 0xf149f2ca
    v_mov_b32 v38, 0
    v_mov_b32 v39, 0
    s_cmp_eq_u32 s36, 0
    s_cbranch_scc1 L_np
    s_setprio 1
L_np:
    v_add_u32 v12, s32, v76
    v_xor_b32 v13, 16, v12
    s_waitcnt vmcnt(15)
    s_barrier
    ds_read_b128 v[112:115], v72 offset:0
    ds_read_b128 v[128:131], v32 offset:0
    ds_read_b128 v[116:119], v73 offset:0
    ds_read_b128 v[132:135], v33 offset:0
    ds_read_b128 v[120:123], v74 offset:0
    ds_read_b128 v[136:139], v34 offset:0
    ds_read_b128 v[124:127], v75 offset:0
    ds_read_b128 v[140:143], v35 offset:0
    s_bfe_u32 s43, s2, 0x20003
    s_mul_i32 s43, s43, 40960
    buffer_load_dword v7, v47, s[24:27], s43 offen
    buffer_load_dword v46, v19, s[4:7], 0 offen
    s_waitcnt lgkmcnt(2)
    ds_read_b64_tr_b16 v[48:49], v12 offset:0
    ds_read_b64_tr_b16 v[50:51], v13 offset:1536
    ds_read_b64_tr_b16 v[52:53], v12 offset:128
    ds_read_b64_tr_b16 v[54:55], v13 offset:1664
    ds_read_b64_tr_b16 v[56:57], v12 offset:256
    ds_read_b64_tr_b16 v[58:59], v13 offset:1792
    ds_read_b64_tr_b16 v[60:61], v12 offset:6144
    ds_read_b64_tr_b16 v[62:63], v13 offset:7680
    ds_read_b64_tr_b16 v[64:65], v12 offset:6272
    ds_read_b64_tr_b16 v[66:67], v13 offset:7808
    ds_read_b64_tr_b16 v[68:69], v12 offset:6400
    ds_read_b64_tr_b16 v[70:71], v13 offset:7936
    s_mov_b32 s38, 3
L_q:
    s_waitcnt lgkmcnt(10)
    v_mfma_f32_32x32x16_bf16 v[160:175], v[48:51], v[112:115], v[160:175]
    s_waitcnt lgkmcnt(8)
    v_mfma_f32_32x32x16_bf16 v[176:191], v[52:55], v[112:115], v[176:191]
    s_waitcnt lgkmcnt(6)
    v_mfma_f32_32x32x16_bf16 v[192:207], v[56:59], v[112:115], v[192:207]
    v_mfma_f32_32x32x16_bf16 v[208:223], v[48:51], v[128:131], v[208:223]
    v_mfma_f32_32x32x16_bf16 v[224:239], v[52:55], v[128:131], v[224:239]
    v_mfma_f32_32x32x16_bf16 v[240:255], v[56:59], v[128:131], v[240:255]
    s_waitcnt lgkmcnt(4)
    v_mfma_f32_32x32x16_bf16 v[160:175], v[60:63], v[116:119], v[160:175]
    s_mov_b32 s33, s32
    s_add_u32 s32, s32, 24576
    s_cmp_eq_u32 s32, 122880
    s_cselect_b32 s32, 0, s32
    s_waitcnt lgkmcnt(2)
    v_mfma_f32_32x32x16_bf16 v[176:191], v[64:67], v[116:119], v[176:191]
    v_add_u32 v12, s32, v76
    v_xor_b32 v13, 16, v12
    s_waitcnt lgkmcnt(0)
    v_mfma_f32_32x32x16_bf16 v[192:207], v[68:71], v[116:119], v[192:207]
    s_waitcnt vmcnt(11) lgkmcnt(0)
    s_barrier
    ds_read_b64_tr_b16 v[48:49], v12 offset:0
    ds_read_b64_tr_b16 v[50:51], v13 offset:1536
    ds_read_b64_tr_b16 v[52:53], v12 offset:128
    ds_read_b64_tr_b16 v[54:55], v13 offset:1664
    ds_read_b64_tr_b16 v[56:57], v12 offset:256
    ds_read_b64_tr_b16 v[58:59], v13 offset:1792
    s_add_u32 m0, s45, 0
    s_nop 0
    v_mfma_f32_32x32x16_bf16 v[208:223], v[60:63], v[132:135], v[208:223]
    ds_read_b64_tr_b16 v[60:61], v12 offset:6144
    ds_read_b64_tr_b16 v[62:63], v13 offset:7680
    buffer_load_dwordx4 v28, s[24:27], s41 offen lds
    buffer_load_dwordx4 v29, s[24:27], s41 offen offset:1024 lds
    s_add_u32 s41, s41, 128
    s_add_u32 m0, s33, s34
    s_nop 0
    v_mfma_f32_32x32x16_bf16 v[224:239], v[64:67], v[132:135], v[224:239]
    ds_read_b64_tr_b16 v[64:65], v12 offset:6272
    ds_read_b64_tr_b16 v[66:67], v13 offset:7808
    buffer_load_dwordx4 v20, s[16:19], s39 offen offset:0  lds
    buffer_load_dwordx4 v21, s[16:19], s39 offen offset:1024  lds
    v_mfma_f32_32x32x16_bf16 v[240:255], v[68:71], v[132:135], v[240:255]
    ds_read_b64_tr_b16 v[68:69], v12 offset:6400
    ds_read_b64_tr_b16 v[70:71], v13 offset:7936
    buffer_load_dwordx4 v22, s[16:19], s39 offen offset:2048  lds
    s_add_u32 s39, s39, 393216
    s_waitcnt lgkmcnt(10)
    v_mfma_f32_32x32x16_bf16 v[160:175], v[48:51], v[120:123], v[160:175]
    s_waitcnt lgkmcnt(8)
    v_mfma_f32_32x32x16_bf16 v[176:191], v[52:55], v[120:123], v[176:191]
    s_waitcnt lgkmcnt(6)
    v_mfma_f32_32x32x16_bf16 v[192:207], v[56:59], v[120:123], v[192:207]
    v_mfma_f32_32x32x16_bf16 v[208:223], v[48:51], v[136:139], v[208:223]
    v_mfma_f32_32x32x16_bf16 v[224:239], v[52:55], v[136:139], v[224:239]
    v_mfma_f32_32x32x16_bf16 v[240:255], v[56:59], v[136:139], v[240:255]
    s_waitcnt lgkmcnt(4)
    v_mfma_f32_32x32x16_bf16 v[160:175], v[60:63], v[124:127], v[160:175]
    s_mov_b32 s33, s32
    s_add_u32 s32, s32, 24576
    s_cmp_eq_u32 s32, 122880
    s_cselect_b32 s32, 0, s32
    s_waitcnt lgkmcnt(2)
    v_mfma_f32_32x32x16_bf16 v[176:191], v[64:67], v[124:127], v[176:191]
    v_add_u32 v12, s32, v76
    v_xor_b32 v13, 16, v12
    s_waitcnt lgkmcnt(0)
    v_mfma_f32_32x32x16_bf16 v[192:207], v[68:71], v[124:127], v[192:207]
    s_waitcnt vmcnt(11) lgkmcnt(0)
    s_barrier
    ds_read_b128 v[80:83], v72 offset:16384
    ds_read_b128 v[96:99], v32 offset:16384
    ds_read_b128 v[84:87], v73 offset:16384
    ds_read_b128 v[100:103], v33 offset:16384
    ds_read_b128 v[88:91], v74 offset:16384
    ds_read_b128 v[104:107], v34 offset:16384
    ds_read_b128 v[92:95], v75 offset:16384
    ds_read_b128 v[108:111], v35 offset:16384
    ds_read_b64_tr_b16 v[48:49], v12 offset:0
    ds_read_b64_tr_b16 v[50:51], v13 offset:1536
    ds_read_b64_tr_b16 v[52:53], v12 offset:128
    ds_read_b64_tr_b16 v[54:55], v13 offset:1664
    ds_read_b64_tr_b16 v[56:57], v12 offset:256
    ds_read_b64_tr_b16 v[58:59], v13 offset:1792
    s_add_u32 m0, s33, s34
    s_nop 0
    v_mfma_f32_32x32x16_bf16 v[208:223], v[60:63], v[140:143], v[208:223]
    s_waitcnt lgkmcnt(12)
    ds_read_b64_tr_b16 v[60:61], v12 offset:6144
    ds_read_b64_tr_b16 v[62:63], v13 offset:7680
    buffer_load_dwordx4 v20, s[16:19], s39 offen offset:0  lds
    v_mfma_f32_32x32x16_bf16 v[224:239], v[64:67], v[140:143], v[224:239]
    s_waitcnt lgkmcnt(12)
    ds_read_b64_tr_b16 v[64:65], v12 offset:6272
    ds_read_b64_tr_b16 v[66:67], v13 offset:7808
    buffer_load_dwordx4 v21, s[16:19], s39 offen offset:1024  lds
    v_mfma_f32_32x32x16_bf16 v[240:255], v[68:71], v[140:143], v[240:255]
    s_waitcnt lgkmcnt(12)
    ds_read_b64_tr_b16 v[68:69], v12 offset:6400
    ds_read_b64_tr_b16 v[70:71], v13 offset:7936
    buffer_load_dwordx4 v22, s[16:19], s39 offen offset:2048  lds
    s_add_u32 s39, s39, 393216
    s_waitcnt lgkmcnt(10)
    v_mfma_f32_32x32x16_bf16 v[160:175], v[48:51], v[80:83], v[160:175]
    s_waitcnt lgkmcnt(8)
    v_mfma_f32_32x32x16_bf16 v[176:191], v[52:55], v[80:83], v[176:191]
    s_waitcnt lgkmcnt(6)
    v_mfma_f32_32x32x16_bf16 v[192:207], v[56:59], v[80:83], v[192:207]
    v_mfma_f32_32x32x16_bf16 v[208:223], v[48:51], v[96:99], v[208:223]
    v_mfma_f32_32x32x16_bf16 v[224:239], v[52:55], v[96:99], v[224:239]
    v_mfma_f32_32x32x16_bf16 v[240:255], v[56:59], v[96:99], v[240:255]
    s_waitcnt lgkmcnt(4)
    v_mfma_f32_32x32x16_bf16 v[160:175], v[60:63], v[84:87], v[160:175]
    s_mov_b32 s33, s32
    s_add_u32 s32, s32, 24576
    s_cmp_eq_u32 s32, 122880
    s_cselect_b32 s32, 0, s32
    s_waitcnt lgkmcnt(2)
    v_mfma_f32_32x32x16_bf16 v[176:191], v[64:67], v[84:87], v[176:191]
    v_add_u32 v12, s32, v76
    v_xor_b32 v13, 16, v12
    s_waitcnt lgkmcnt(0)
    v_mfma_f32_32x32x16_bf16 v[192:207], v[68:71], v[84:87], v[192:207]
    s_waitcnt vmcnt(11) lgkmcnt(0)
    s_barrier
    ds_read_b64_tr_b16 v[48:49], v12 offset:0
    ds_read_b64_tr_b16 v[50:51], v13 offset:1536
    ds_read_b64_tr_b16 v[52:53], v12 offset:128
    ds_read_b64_tr_b16 v[54:55], v13 offset:1664
    ds_read_b64_tr_b16 v[56:57], v12 offset:256
    ds_read_b64_tr_b16 v[58:59], v13 offset:1792
    s_add_u32 m0, s45, 16384
    s_nop 0
    v_mfma_f32_32x32x16_bf16 v[208:223], v[60:63], v[100:103], v[208:223]
    ds_read_b64_tr_b16 v[60:61], v12 offset:6144
    ds_read_b64_tr_b16 v[62:63], v13 offset:7680
    buffer_load_dwordx4 v28, s[24:27], s41 offen lds
    buffer_load_dwordx4 v29, s[24:27], s41 offen offset:1024 lds
    s_add_u32 s41, s41, 128
    s_add_u32 m0, s33, s34
    s_nop 0
    v_mfma_f32_32x32x16_bf16 v[224:239], v[64:67], v[100:103], v[224:239]
    ds_read_b64_tr_b16 v[64:65], v12 offset:6272
    ds_read_b64_tr_b16 v[66:67], v13 offset:7808
    buffer_load_dwordx4 v20, s[16:19], s39 offen offset:0  lds
    buffer_load_dwordx4 v21, s[16:19], s39 offen offset:1024  lds
    v_mfma_f32_32x32x16_bf16 v[240:255], v[68:71], v[100:103], v[240:255]
    ds_read_b64_tr_b16 v[68:69], v12 offset:6400
    ds_read_b64_tr_b16 v[70:71], v13 offset:7936
    buffer_load_dwordx4 v22, s[16:19], s39 offen offset:2048  lds
    s_add_u32 s39, s39, 393216
    s_waitcnt lgkmcnt(10)
    v_mfma_f32_32x32x16_bf16 v[160:175], v[48:51], v[88:91], v[160:175]
    s_waitcnt lgkmcnt(8)
    v_mfma_f32_32x32x16_bf16 v[176:191], v[52:55], v[88:91], v[176:191]
    s_waitcnt lgkmcnt(6)
    v_mfma_f32_32x32x16_bf16 v[192:207], v[56:59], v[88:91], v[192:207]
    v_mfma_f32_32x32x16_bf16 v[208:223], v[48:51], v[104:107], v[208:223]
    v_mfma_f32_32x32x16_bf16 v[224:239], v[52:55], v[104:107], v[224:239]
    v_mfma_f32_32x32x16_bf16 v[240:255], v[56:59], v[104:107], v[240:255]
    s_waitcnt lgkmcnt(4)
    v_mfma_f32_32x32x16_bf16 v[160:175], v[60:63], v[92:95], v[160:175]
    s_mov_b32 s33, s32
    s_add_u32 s32, s32, 24576
    s_cmp_eq_u32 s32, 122880
    s_cselect_b32 s32, 0, s32
    s_waitcnt lgkmcnt(2)
    v_mfma_f32_32x32x16_bf16 v[176:191], v[64:67], v[92:95], v[176:191]
    v_add_u32 v12, s32, v76
    v_xor_b32 v13, 16, v12
    s_waitcnt lgkmcnt(0)
    v_mfma_f32_32x32x16_bf16 v[192:207], v[68:71], v[92:95], v[192:207]
    s_waitcnt vmcnt(11) lgkmcnt(0)
    s_barrier
    ds_read_b128 v[112:115], v72 offset:0
    ds_read_b128 v[128:131], v32 offset:0
    ds_read_b128 v[116:119], v73 offset:0
    ds_read_b128 v[132:135], v33 offset:0
    ds_read_b128 v[120:123], v74 offset:0
    ds_read_b128 v[136:139], v34 offset:0
    ds_read_b128 v[124:127], v75 offset:0
    ds_read_b128 v[140:143], v35 offset:0
    ds_read_b64_tr_b16 v[48:49], v12 offset:0
    ds_read_b64_tr_b16 v[50:51], v13 offset:1536
    ds_read_b64_tr_b16 v[52:53], v12 offset:128
    ds_read_b64_tr_b16 v[54:55], v13 offset:1664
    ds_read_b64_tr_b16 v[56:57], v12 offset:256
    ds_read_b64_tr_b16 v[58:59], v13 offset:1792
    s_add_u32 m0, s33, s34
    s_nop 0
    v_mfma_f32_32x32x16_bf16 v[208:223], v[60:63], v[108:111], v[208:223]
    s_waitcnt lgkmcnt(12)
    ds_read_b64_tr_b16 v[60:61], v12 offset:6144
    ds_read_b64_tr_b16 v[62:63], v13 offset:7680
    buffer_load_dwordx4 v20, s[16:19], s39 offen offset:0  lds
    v_mfma_f32_32x32x16_bf16 v[224:239], v[64:67], v[108:111], v[224:239]
    s_waitcnt lgkmcnt(12)
    ds_read_b64_tr_b16 v[64:65], v12 offset:6272
    ds_read_b64_tr_b16 v[66:67], v13 offset:7808
    buffer_load_dwordx4 v21, s[16:19], s39 offen offset:1024  lds
    v_mfma_f32_32x32x16_bf16 v[240:255], v[68:71], v[108:111], v[240:255]
    s_waitcnt lgkmcnt(12)
    ds_read_b64_tr_b16 v[68:69], v12 offset:6400
    ds_read_b64_tr_b16 v[70:71], v13 offset:7936
    buffer_load_dwordx4 v22, s[16:19], s39 offen offset:2048  lds
    s_add_u32 s39, s39, 393216
    s_sub_u32 s38, s38, 1
    s_cmp_lg_u32 s38, 0
    s_cbranch_scc1 L_q
    s_waitcnt lgkmcnt(10)
    v_mfma_f32_32x32x16_bf16 v[160:175], v[48:51], v[112:115], v[160:175]
    s_waitcnt lgkmcnt(8)
    v_mfma_f32_32x32x16_bf16 v[176:191], v[52:55], v[112:115], v[176:191]
    s_waitcnt lgkmcnt(6)
    v_mfma_f32_32x32x16_bf16 v[192:207], v[56:59], v[112:115], v[192:207]
    v_mfma_f32_32x32x16_bf16 v[208:223], v[48:51], v[128:131], v[208:223]
    v_mfma_f32_32x32x16_bf16 v[224:239], v[52:55], v[128:131], v[224:239]
    v_mfma_f32_32x32x16_bf16 v[240:255], v[56:59], v[128:131], v[240:255]
    s_waitcnt lgkmcnt(4)
    v_mfma_f32_32x32x16_bf16 v[160:175], v[60:63], v[116:119], v[160:175]
    s_mov_b32 s33, s32
    s_add_u32 s32, s32, 24576
    s_cmp_eq_u32 s32, 122880
    s_cselect_b32 s32, 0, s32
    s_waitcnt lgkmcnt(2)
    v_mfma_f32_32x32x16_bf16 v[176:191], v[64:67], v[116:119], v[176:191]
    v_add_u32 v12, s32, v76
    v_xor_b32 v13, 16, v12
    s_waitcnt lgkmcnt(0)
    v_mfma_f32_32x32x16_bf16 v[192:207], v[68:71], v[116:119], v[192:207]
    s_waitcnt vmcnt(11) lgkmcnt(0)
    s_barrier
    ds_read_b64_tr_b16 v[48:49], v12 offset:0
    ds_read_b64_tr_b16 v[50:51], v13 offset:1536
    ds_read_b64_tr_b16 v[52:53], v12 offset:128
    ds_read_b64_tr_b16 v[54:55], v13 offset:1664
    ds_read_b64_tr_b16 v[56:57], v12 offset:256
    ds_read_b64_tr_b16 v[58:59], v13 offset:1792
    s_add_u32 m0, s45, 0
    s_nop 0
    v_mfma_f32_32x32x16_bf16 v[208:223], v[60:63], v[132:135], v[208:223]
    ds_read_b64_tr_b16 v[60:61], v12 offset:6144
    ds_read_b64_tr_b16 v[62:63], v13 offset:7680
    buffer_load_dwordx4 v28, s[24:27], s41 offen lds
    buffer_load_dwordx4 v29, s[24:27], s41 offen offset:1024 lds
    s_add_u32 s41, s41, 128
    s_add_u32 m0, s33, s34
    s_nop 0
    v_mfma_f32_32x32x16_bf16 v[224:239], v[64:67], v[132:135], v[224:239]
    ds_read_b64_tr_b16 v[64:65], v12 offset:6272
    ds_read_b64_tr_b16 v[66:67], v13 offset:7808
    buffer_load_dwordx4 v20, s[16:19], s39 offen offset:0  lds
    buffer_load_dwordx4 v21, s[16:19], s39 offen offset:1024  lds
    v_mfma_f32_32x32x16_bf16 v[240:255], v[68:71], v[132:135], v[240:255]
    ds_read_b64_tr_b16 v[68:69], v12 offset:6400
    ds_read_b64_tr_b16 v[70:71], v13 offset:7936
    buffer_load_dwordx4 v22, s[16:19], s39 offen offset:2048  lds
    s_add_u32 s39, s39, 393216
    s_waitcnt lgkmcnt(10)
    v_mfma_f32_32x32x16_bf16 v[160:175], v[48:51], v[120:123], v[160:175]
    s_waitcnt lgkmcnt(8)
    v_mfma_f32_32x32x16_bf16 v[176:191], v[52:55], v[120:123], v[176:191]
    s_waitcnt lgkmcnt(6)
    v_mfma_f32_32x32x16_bf16 v[192:207], v[56:59], v[120:123], v[192:207]
    v_mfma_f32_32x32x16_bf16 v[208:223], v[48:51], v[136:139], v[208:223]
    v_mfma_f32_32x32x16_bf16 v[224:239], v[52:55], v[136:139], v[224:239]
    v_mfma_f32_32x32x16_bf16 v[240:255], v[56:59], v[136:139], v[240:255]
    s_waitcnt lgkmcnt(4)
    v_mfma_f32_32x32x16_bf16 v[160:175], v[60:63], v[124:127], v[160:175]
    s_mov_b32 s33, s32
    s_add_u32 s32, s32, 24576
    s_cmp_eq_u32 s32, 122880
    s_cselect_b32 s32, 0, s32
    s_waitcnt lgkmcnt(2)
    v_mfma_f32_32x32x16_bf16 v[176:191], v[64:67], v[124:127], v[176:191]
    v_add_u32 v12, s32, v76
    v_xor_b32 v13, 16, v12
    s_waitcnt lgkmcnt(0)
    v_mfma_f32_32x32x16_bf16 v[192:207], v[68:71], v[124:127], v[192:207]
    s_waitcnt vmcnt(11) lgkmcnt(0)
    s_barrier
    ds_read_b128 v[80:83], v72 offset:16384
    ds_read_b128 v[96:99], v32 offset:16384
    ds_read_b128 v[84:87], v73 offset:16384
    ds_read_b128 v[100:103], v33 offset:16384
    ds_read_b128 v[88:91], v74 offset:16384
    ds_read_b128 v[104:107], v34 offset:16384
    ds_read_b128 v[92:95], v75 offset:16384
    ds_read_b128 v[108:111], v35 offset:16384
    ds_read_b64_tr_b16 v[48:49], v12 offset:0
    ds_read_b64_tr_b16 v[50:51], v13 offset:1536
    ds_read_b64_tr_b16 v[52:53], v12 offset:128
    ds_read_b64_tr_b16 v[54:55], v13 offset:1664
    ds_read_b64_tr_b16 v[56:57], v12 offset:256
    ds_read_b64_tr_b16 v[58:59], v13 offset:1792
    s_add_u32 m0, s33, s34
    s_nop 0
    v_mfma_f32_32x32x16_bf16 v[208:223], v[60:63], v[140:143], v[208:223]
    s_waitcnt lgkmcnt(12)
    ds_read_b64_tr_b16 v[60:61], v12 offset:6144
    ds_read_b64_tr_b16 v[62:63], v13 offset:7680
    buffer_load_dwordx4 v20, s[16:19], s39 offen offset:0  lds
    v_mfma_f32_32x32x16_bf16 v[224:239], v[64:67], v[140:143], v[224:239]
    s_waitcnt lgkmcnt(12)
    ds_read_b64_tr_b16 v[64:65], v12 offset:6272
    ds_read_b64_tr_b16 v[66:67], v13 offset:7808
    buffer_load_dwordx4 v21, s[16:19], s39 offen offset:1024  lds
    v_mfma_f32_32x32x16_bf16 v[240:255], v[68:71], v[140:143], v[240:255]
    s_waitcnt lgkmcnt(12)
    ds_read_b64_tr_b16 v[68:69], v12 offset:6400
    ds_read_b64_tr_b16 v[70:71], v13 offset:7936
    buffer_load_dwordx4 v22, s[16:19], s39 offen offset:2048  lds
    s_add_u32 s39, s39, 393216
    s_waitcnt lgkmcnt(10)
    v_mfma_f32_32x32x16_bf16 v[160:175], v[48:51], v[80:83], v[160:175]
    s_waitcnt lgkmcnt(8)
    v_mfma_f32_32x32x16_bf16 v[176:191], v[52:55], v[80:83], v[176:191]
    s_waitcnt lgkmcnt(6)
    v_mfma_f32_32x32x16_bf16 v[192:207], v[56:59], v[80:83], v[192:207]
    v_mfma_f32_32x32x16_bf16 v[208:223], v[48:51], v[96:99], v[208:223]
    v_mfma_f32_32x32x16_bf16 v[224:239], v[52:55], v[96:99], v[224:239]
    v_mfma_f32_32x32x16_bf16 v[240:255], v[56:59], v[96:99], v[240:255]
    s_waitcnt lgkmcnt(4)
    v_mfma_f32_32x32x16_bf16 v[160:175], v[60:63], v[84:87], v[160:175]
    s_mov_b32 s33, s32
    s_add_u32 s32, s32, 24576
    s_cmp_eq_u32 s32, 122880
    s_cselect_b32 s32, 0, s32
    s_waitcnt lgkmcnt(2)
    v_mfma_f32_32x32x16_bf16 v[176:191], v[64:67], v[84:87], v[176:191]
    v_add_u32 v12, s32, v76
    v_xor_b32 v13, 16, v12
    s_waitcnt lgkmcnt(0)
    v_mfma_f32_32x32x16_bf16 v[192:207], v[68:71], v[84:87], v[192:207]
    s_waitcnt vmcnt(11) lgkmcnt(0)
    s_barrier
    ds_read_b64_tr_b16 v[48:49], v12 offset:0
    ds_read_b64_tr_b16 v[50:51], v13 offset:1536
    ds_read_b64_tr_b16 v[52:53], v12 offset:128
    ds_read_b64_tr_b16 v[54:55], v13 offset:1664
    ds_read_b64_tr_b16 v[56:57], v12 offset:256
    ds_read_b64_tr_b16 v[58:59], v13 offset:1792
    s_add_u32 m0, s45, 16384
    s_nop 0
    v_mfma_f32_32x32x16_bf16 v[208:223], v[60:63], v[100:103], v[208:223]
    ds_read_b64_tr_b16 v[60:61], v12 offset:6144
    ds_read_b64_tr_b16 v[62:63], v13 offset:7680
    buffer_load_dwordx4 v28, s[24:27], s41 offen lds
    buffer_load_dwordx4 v29, s[24:27], s41 offen offset:1024 lds
    s_add_u32 s41, s41, 128
    s_add_u32 m0, s33, s34
    s_nop 0
    v_mfma_f32_32x32x16_bf16 v[224:239], v[64:67], v[100:103], v[224:239]
    ds_read_b64_tr_b16 v[64:65], v12 offset:6272
    ds_read_b64_tr_b16 v[66:67], v13 offset:7808
    buffer_load_dwordx4 v20, s[16:19], s39 offen offset:0  lds
    buffer_load_dwordx4 v21, s[16:19], s39 offen offset:1024  lds
    v_mfma_f32_32x32x16_bf16 v[240:255], v[68:71], v[100:103], v[240:255]
    ds_read_b64_tr_b16 v[68:69], v12 offset:6400
    ds_read_b64_tr_b16 v[70:71], v13 offset:7936
    buffer_load_dwordx4 v22, s[16:19], s39 offen offset:2048  lds
    s_add_u32 s39, s39, 393216
    s_waitcnt lgkmcnt(10)
    v_mfma_f32_32x32x16_bf16 v[160:175], v[48:51], v[88:91], v[160:175]
    s_waitcnt lgkmcnt(8)
    v_mfma_f32_32x32x16_bf16 v[176:191], v[52:55], v[88:91], v[176:191]
    s_waitcnt lgkmcnt(6)
    v_mfma_f32_32x32x16_bf16 v[192:207], v[56:59], v[88:91], v[192:207]
    v_mfma_f32_32x32x16_bf16 v[208:223], v[48:51], v[104:107], v[208:223]
    v_mfma_f32_32x32x16_bf16 v[224:239], v[52:55], v[104:107], v[224:239]
    v_mfma_f32_32x32x16_bf16 v[240:255], v[56:59], v[104:107], v[240:255]
    s_waitcnt lgkmcnt(4)
    v_mfma_f32_32x32x16_bf16 v[160:175], v[60:63], v[92:95], v[160:175]
    s_mov_b32 s33, s32
    s_add_u32 s32, s32, 24576
    s_cmp_eq_u32 s32, 122880
    s_cselect_b32 s32, 0, s32
    s_waitcnt lgkmcnt(2)
    v_mfma_f32_32x32x16_bf16 v[176:191], v[64:67], v[92:95], v[176:191]
    v_add_u32 v12, s32, v76
    v_xor_b32 v13, 16, v12
    s_waitcnt lgkmcnt(0)
    v_mfma_f32_32x32x16_bf16 v[192:207], v[68:71], v[92:95], v[192:207]
    s_waitcnt vmcnt(11) lgkmcnt(0)
    s_barrier
    ds_read_b128 v[112:115], v72 offset:0
    ds_read_b128 v[128:131], v32 offset:0
    ds_read_b128 v[116:119], v73 offset:0
    ds_read_b128 v[132:135], v33 offset:0
    ds_read_b128 v[120:123], v74 offset:0
    ds_read_b128 v[136:139], v34 offset:0
    ds_read_b128 v[124:127], v75 offset:0
    ds_read_b128 v[140:143], v35 offset:0
    ds_read_b64_tr_b16 v[48:49], v12 offset:0
    ds_read_b64_tr_b16 v[50:51], v13 offset:1536
    ds_read_b64_tr_b16 v[52:53], v12 offset:128
    ds_read_b64_tr_b16 v[54:55], v13 offset:1664
    ds_read_b64_tr_b16 v[56:57], v12 offset:256
    ds_read_b64_tr_b16 v[58:59], v13 offset:1792
    s_add_u32 m0, s33, s34
    s_nop 0
    v_mfma_f32_32x32x16_bf16 v[208:223], v[60:63], v[108:111], v[208:223]
    s_waitcnt lgkmcnt(12)
    ds_read_b64_tr_b16 v[60:61], v12 offset:6144
    ds_read_b64_tr_b16 v[62:63], v13 offset:7680
    buffer_load_dwordx4 v16, s[8:11], s40 offen offset:0  lds
    v_mfma_f32_32x32x16_bf16 v[224:239], v[64:67], v[108:111], v[224:239]
    s_waitcnt lgkmcnt(12)
    ds_read_b64_tr_b16 v[64:65], v12 offset:6272
    ds_read_b64_tr_b16 v[66:67], v13 offset:7808
    buffer_load_dwordx4 v17, s[8:11], s40 offen offset:1024  lds
    v_mfma_f32_32x32x16_bf16 v[240:255], v[68:71], v[108:111], v[240:255]
    s_waitcnt lgkmcnt(12)
    ds_read_b64_tr_b16 v[68:69], v12 offset:6400
    ds_read_b64_tr_b16 v[70:71], v13 offset:7936
    buffer_load_dwordx4 v18, s[8:11], s40 offen offset:2048  lds
    s_add_u32 s40, s40, 12288
    s_cmp_eq_u32 s40, 196608
    s_cselect_b32 s40, 0, s40
    s_waitcnt lgkmcnt(10)
    v_mfma_f32_32x32x16_bf16 v[160:175], v[48:51], v[112:115], v[160:175]
    s_waitcnt lgkmcnt(8)
    v_mfma_f32_32x32x16_bf16 v[176:191], v[52:55], v[112:115], v[176:191]
    s_waitcnt lgkmcnt(6)
    v_mfma_f32_32x32x16_bf16 v[192:207], v[56:59], v[112:115], v[192:207]
    v_mfma_f32_32x32x16_bf16 v[208:223], v[48:51], v[128:131], v[208:223]
    v_mfma_f32_32x32x16_bf16 v[224:239], v[52:55], v[128:131], v[224:239]
    v_mfma_f32_32x32x16_bf16 v[240:255], v[56:59], v[128:131], v[240:255]
    s_waitcnt lgkmcnt(4)
    v_mfma_f32_32x32x16_bf16 v[160:175], v[60:63], v[116:119], v[160:175]
    s_mov_b32 s33, s32
    s_add_u32 s32, s32, 24576
    s_cmp_eq_u32 s32, 122880
    s_cselect_b32 s32, 0, s32
    s_waitcnt lgkmcnt(2)
    v_mfma_f32_32x32x16_bf16 v[176:191], v[64:67], v[116:119], v[176:191]
    v_add_u32 v12, s32, v76
    v_xor_b32 v13, 16, v12
    s_waitcnt lgkmcnt(0)
    v_mfma_f32_32x32x16_bf16 v[192:207], v[68:71], v[116:119], v[192:207]
    s_waitcnt vmcnt(11) lgkmcnt(0)
    s_barrier
    ds_read_b64_tr_b16 v[48:49], v12 offset:0
    ds_read_b64_tr_b16 v[50:51], v13 offset:1536
    ds_read_b64_tr_b16 v[52:53], v12 offset:128
    ds_read_b64_tr_b16 v[54:55], v13 offset:1664
    ds_read_b64_tr_b16 v[56:57], v12 offset:256
    ds_read_b64_tr_b16 v[58:59], v13 offset:1792
    s_add_u32 m0, s33, s34
    s_nop 0
    v_mfma_f32_32x32x16_bf16 v[208:223], v[60:63], v[132:135], v[208:223]
    ds_read_b64_tr_b16 v[60:61], v12 offset:6144
    ds_read_b64_tr_b16 v[62:63], v13 offset:7680
    buffer_load_dwordx4 v16, s[8:11], s40 offen offset:0  lds
    v_mfma_f32_32x32x16_bf16 v[224:239], v[64:67], v[132:135], v[224:239]
    ds_read_b64_tr_b16 v[64:65], v12 offset:6272
    ds_read_b64_tr_b16 v[66:67], v13 offset:7808
    buffer_load_dwordx4 v17, s[8:11], s40 offen offset:1024  lds
    v_mfma_f32_32x32x16_bf16 v[240:255], v[68:71], v[132:135], v[240:255]
    ds_read_b64_tr_b16 v[68:69], v12 offset:6400
    ds_read_b64_tr_b16 v[70:71], v13 offset:7936
    buffer_load_dwordx4 v18, s[8:11], s40 offen offset:2048  lds
    s_add_u32 s40, s40, 12288
    s_cmp_eq_u32 s40, 196608
    s_cselect_b32 s40, 0, s40
    s_waitcnt lgkmcnt(10)
    v_mfma_f32_32x32x16_bf16 v[160:175], v[48:51], v[120:123], v[160:175]
    s_waitcnt lgkmcnt(8)
    v_mfma_f32_32x32x16_bf16 v[176:191], v[52:55], v[120:123], v[176:191]
    s_waitcnt lgkmcnt(6)
    v_mfma_f32_32x32x16_bf16 v[192:207], v[56:59], v[120:123], v[192:207]
    v_mfma_f32_32x32x16_bf16 v[208:223], v[48:51], v[136:139], v[208:223]
    v_mfma_f32_32x32x16_bf16 v[224:239], v[52:55], v[136:139], v[224:239]
    v_mfma_f32_32x32x16_bf16 v[240:255], v[56:59], v[136:139], v[240:255]
    s_waitcnt lgkmcnt(4)
    v_mfma_f32_32x32x16_bf16 v[160:175], v[60:63], v[124:127], v[160:175]
    s_mov_b32 s33, s32
    s_add_u32 s32, s32, 24576
    s_cmp_eq_u32 s32, 122880
    s_cselect_b32 s32, 0, s32
    s_waitcnt lgkmcnt(2)
    v_mfma_f32_32x32x16_bf16 v[176:191], v[64:67], v[124:127], v[176:191]
    v_add_u32 v12, s32, v76
    v_xor_b32 v13, 16, v12
    s_waitcnt lgkmcnt(0)
    v_mfma_f32_32x32x16_bf16 v[192:207], v[68:71], v[124:127], v[192:207]
    s_waitcnt vmcnt(9) lgkmcnt(0)
    s_barrier
    ds_read_b128 v[80:83], v72 offset:16384
    ds_read_b128 v[96:99], v32 offset:16384
    ds_read_b128 v[84:87], v73 offset:16384
    ds_read_b128 v[100:103], v33 offset:16384
    ds_read_b128 v[88:91], v74 offset:16384
    ds_read_b128 v[104:107], v34 offset:16384
    ds_read_b128 v[92:95], v75 offset:16384
    ds_read_b128 v[108:111], v35 offset:16384
    ds_read_b64_tr_b16 v[48:49], v12 offset:0
    ds_read_b64_tr_b16 v[50:51], v13 offset:1536
    ds_read_b64_tr_b16 v[52:53], v12 offset:128
    ds_read_b64_tr_b16 v[54:55], v13 offset:1664
    ds_read_b64_tr_b16 v[56:57], v12 offset:256
    ds_read_b64_tr_b16 v[58:59], v13 offset:1792
    s_add_u32 m0, s33, s34
    s_nop 0
    v_mfma_f32_32x32x16_bf16 v[208:223], v[60:63], v[140:143], v[208:223]
    s_waitcnt lgkmcnt(12)
    ds_read_b64_tr_b16 v[60:61], v12 offset:6144
    ds_read_b64_tr_b16 v[62:63], v13 offset:7680
    buffer_load_dwordx4 v16, s[12:15], s74 offen offset:0  lds
    v_mfma_f32_32x32x16_bf16 v[224:239], v[64:67], v[140:143], v[224:239]
    s_waitcnt lgkmcnt(12)
    ds_read_b64_tr_b16 v[64:65], v12 offset:6272
    ds_read_b64_tr_b16 v[66:67], v13 offset:7808
    buffer_load_dwordx4 v17, s[12:15], s74 offen offset:1024  lds
    v_mfma_f32_32x32x16_bf16 v[240:255], v[68:71], v[140:143], v[240:255]
    s_waitcnt lgkmcnt(12)
    ds_read_b64_tr_b16 v[68:69], v12 offset:6400
    ds_read_b64_tr_b16 v[70:71], v13 offset:7936
    buffer_load_dwordx4 v18, s[12:15], s74 offen offset:2048  lds
    s_add_u32 s74, s74, 12288
    s_cmp_eq_u32 s74, 196608
    s_cselect_b32 s74, 0, s74
    s_waitcnt lgkmcnt(10)
    v_mfma_f32_32x32x16_bf16 v[160:175], v[48:51], v[80:83], v[160:175]
    s_waitcnt lgkmcnt(8)
    v_mfma_f32_32x32x16_bf16 v[176:191], v[52:55], v[80:83], v[176:191]
    s_waitcnt lgkmcnt(6)
    v_mfma_f32_32x32x16_bf16 v[192:207], v[56:59], v[80:83], v[192:207]
    v_mfma_f32_32x32x16_bf16 v[208:223], v[48:51], v[96:99], v[208:223]
    v_mfma_f32_32x32x16_bf16 v[224:239], v[52:55], v[96:99], v[224:239]
    v_mfma_f32_32x32x16_bf16 v[240:255], v[56:59], v[96:99], v[240:255]
    s_waitcnt lgkmcnt(4)
    v_mfma_f32_32x32x16_bf16 v[160:175], v[60:63], v[84:87], v[160:175]
    s_mov_b32 s33, s32
    s_add_u32 s32, s32, 24576
    s_cmp_eq_u32 s32, 122880
    s_cselect_b32 s32, 0, s32
    s_waitcnt lgkmcnt(2)
    v_mfma_f32_32x32x16_bf16 v[176:191], v[64:67], v[84:87], v[176:191]
    v_add_u32 v12, s32, v76
    v_xor_b32 v13, 16, v12
    s_waitcnt lgkmcnt(0)
    v_mfma_f32_32x32x16_bf16 v[192:207], v[68:71], v[84:87], v[192:207]
    s_waitcnt vmcnt(9) lgkmcnt(0)
    s_barrier
    ds_read_b64_tr_b16 v[48:49], v12 offset:0
    ds_read_b64_tr_b16 v[50:51], v13 offset:1536
    ds_read_b64_tr_b16 v[52:53], v12 offset:128
    ds_read_b64_tr_b16 v[54:55], v13 offset:1664
    ds_read_b64_tr_b16 v[56:57], v12 offset:256
    ds_read_b64_tr_b16 v[58:59], v13 offset:1792
    s_add_u32 m0, s33, s34
    s_nop 0
    v_mfma_f32_32x32x16_bf16 v[208:223], v[60:63], v[100:103], v[208:223]
    ds_read_b64_tr_b16 v[60:61], v12 offset:6144
    ds_read_b64_tr_b16 v[62:63], v13 offset:7680
    buffer_load_dwordx4 v16, s[8:11], s40 offen offset:0  lds
    v_mfma_f32_32x32x16_bf16 v[224:239], v[64:67], v[100:103], v[224:239]
    ds_read_b64_tr_b16 v[64:65], v12 offset:6272
    ds_read_b64_tr_b16 v[66:67], v13 offset:7808
    buffer_load_dwordx4 v17, s[8:11], s40 offen offset:1024  lds
    v_mfma_f32_32x32x16_bf16 v[240:255], v[68:71], v[100:103], v[240:255]
    ds_read_b64_tr_b16 v[68:69], v12 offset:6400
    ds_read_b64_tr_b16 v[70:71], v13 offset:7936
    buffer_load_dwordx4 v18, s[8:11], s40 offen offset:2048  lds
    s_add_u32 s40, s40, 12288
    s_cmp_eq_u32 s40, 196608
    s_cselect_b32 s40, 0, s40
    s_waitcnt lgkmcnt(10)
    v_mfma_f32_32x32x16_bf16 v[160:175], v[48:51], v[88:91], v[160:175]
    s_waitcnt lgkmcnt(8)
    v_mfma_f32_32x32x16_bf16 v[176:191], v[52:55], v[88:91], v[176:191]
    s_waitcnt lgkmcnt(6)
    v_mfma_f32_32x32x16_bf16 v[192:207], v[56:59], v[88:91], v[192:207]
    v_mfma_f32_32x32x16_bf16 v[208:223], v[48:51], v[104:107], v[208:223]
    v_mfma_f32_32x32x16_bf16 v[224:239], v[52:55], v[104:107], v[224:239]
    v_mfma_f32_32x32x16_bf16 v[240:255], v[56:59], v[104:107], v[240:255]
    s_waitcnt lgkmcnt(4)
    v_mfma_f32_32x32x16_bf16 v[160:175], v[60:63], v[92:95], v[160:175]
    s_mov_b32 s33, s32
    s_add_u32 s32, s32, 24576
    s_cmp_eq_u32 s32, 122880
    s_cselect_b32 s32, 0, s32
    s_waitcnt lgkmcnt(2)
    v_mfma_f32_32x32x16_bf16 v[176:191], v[64:67], v[92:95], v[176:191]
    v_add_u32 v12, s32, v8
    v_xor_b32 v13, 32, v12
    v_xor_b32 v14, 64, v12
    v_xor_b32 v15, 96, v12
    s_waitcnt lgkmcnt(0)
    v_mfma_f32_32x32x16_bf16 v[192:207], v[68:71], v[92:95], v[192:207]
    s_waitcnt vmcnt(9) lgkmcnt(0)
    s_barrier
    ds_read_b128 v[48:51], v12 offset:0
    ds_read_b128 v[52:55], v13 offset:0
    ds_read_b128 v[56:59], v14 offset:0
    v_mfma_f32_32x32x16_bf16 v[208:223], v[60:63], v[108:111], v[208:223]
    v_cvt_pk_bf16_f32 v120, v160, v161
    v_cvt_pk_bf16_f32 v121, v162, v163
    v_cvt_pk_bf16_f32 v122, v164, v165
    v_cvt_pk_bf16_f32 v123, v166, v167
    v_cvt_pk_bf16_f32 v124, v168, v169
    v_cvt_pk_bf16_f32 v125, v170, v171
    v_cvt_pk_bf16_f32 v126, v172, v173
    v_cvt_pk_bf16_f32 v127, v174, v175
    ds_read_b128 v[60:63], v15 offset:0
    v_mfma_f32_32x32x16_bf16 v[224:239], v[64:67], v[108:111], v[224:239]
    v_cvt_pk_bf16_f32 v136, v176, v177
    v_cvt_pk_bf16_f32 v137, v178, v179
    v_cvt_pk_bf16_f32 v138, v180, v181
    v_cvt_pk_bf16_f32 v139, v182, v183
    v_cvt_pk_bf16_f32 v140, v184, v185
    v_cvt_pk_bf16_f32 v141, v186, v187
    v_cvt_pk_bf16_f32 v142, v188, v189
    v_cvt_pk_bf16_f32 v143, v190, v191
    ds_read_b128 v[64:67], v12 offset:128
    v_mfma_f32_32x32x16_bf16 v[240:255], v[68:71], v[108:111], v[240:255]
    v_cvt_pk_bf16_f32 v152, v192, v193
    v_cvt_pk_bf16_f32 v153, v194, v195
    v_cvt_pk_bf16_f32 v154, v196, v197
    v_cvt_pk_bf16_f32 v155, v198, v199
    v_cvt_pk_bf16_f32 v156, v200, v201
    v_cvt_pk_bf16_f32 v157, v202, v203
    v_cvt_pk_bf16_f32 v158, v204, v205
    v_cvt_pk_bf16_f32 v159, v206, v207
    ds_read_b128 v[68:71], v13 offset:128
    s_mov_b32 s39, 0
    ds_write_b128 v77, v[120:123] offset:0
    ds_write_b128 v77, v[124:127] offset:1024
    ds_write_b128 v77, v[136:139] offset:2048
    ds_write_b128 v77, v[140:143] offset:3072
    ds_write_b128 v77, v[152:155] offset:4096
    ds_write_b128 v77, v[156:159] offset:5120
    v_cvt_pk_bf16_f32 v112, v208, v209
    v_cvt_pk_bf16_f32 v113, v210, v211
    v_cvt_pk_bf16_f32 v114, v212, v213
    v_cvt_pk_bf16_f32 v115, v214, v215
    v_cvt_pk_bf16_f32 v116, v216, v217
    v_cvt_pk_bf16_f32 v117, v218, v219
    v_cvt_pk_bf16_f32 v118, v220, v221
    v_cvt_pk_bf16_f32 v119, v222, v223
    v_cvt_pk_bf16_f32 v128, v224, v225
    v_cvt_pk_bf16_f32 v129, v226, v227
    v_cvt_pk_bf16_f32 v130, v228, v229
    v_cvt_pk_bf16_f32 v131, v230, v231
    v_cvt_pk_bf16_f32 v132, v232, v233
    v_cvt_pk_bf16_f32 v133, v234, v235
    v_cvt_pk_bf16_f32 v134, v236, v237
    v_cvt_pk_bf16_f32 v135, v238, v239
    s_waitcnt lgkmcnt(0)
    s_barrier
    ds_read_b128 v[120:123], v78 offset:0
    ds_read_b128 v[124:127], v78 offset:1024
    ds_read_b128 v[136:139], v78 offset:2048
    ds_read_b128 v[140:143], v78 offset:3072
    ds_read_b128 v[152:155], v78 offset:4096
    ds_read_b128 v[156:159], v78 offset:5120
    v_cvt_pk_bf16_f32 v144, v240, v241
    v_cvt_pk_bf16_f32 v145, v242, v243
    v_cvt_pk_bf16_f32 v146, v244, v245
    v_cvt_pk_bf16_f32 v147, v246, v247
    v_cvt_pk_bf16_f32 v148, v248, v249
    v_cvt_pk_bf16_f32 v149, v250, v251
    v_cvt_pk_bf16_f32 v150, v252, v253
    v_cvt_pk_bf16_f32 v151, v254, v255
    v_mov_b32 v160, 0
    v_mov_b32 v161, 0
    v_mov_b32 v162, 0
    v_mov_b32 v163, 0
    v_mov_b32 v164, 0
    v_mov_b32 v165, 0
    v_mov_b32 v166, 0
    v_mov_b32 v167, 0
    v_mov_b32 v168, 0
    v_mov_b32 v169, 0
    v_mov_b32 v170, 0
    v_mov_b32 v171, 0
    v_mov_b32 v172, 0
    v_mov_b32 v173, 0
    v_mov_b32 v174, 0
    v_mov_b32 v175, 0
    v_mov_b32 v176, 0
    v_mov_b32 v177, 0
    v_mov_b32 v178, 0
    v_mov_b32 v179, 0
    v_mov_b32 v180, 0
    v_mov_b32 v181, 0
    v_mov_b32 v182, 0
    v_mov_b32 v183, 0
    s_waitcnt lgkmcnt(0)
    s_waitcnt lgkmcnt(5)
    v_mfma_f32_32x32x16_bf16 v[80:95], v[48:51], v[112:115], 0
    ds_read_b128 v[48:51], v14 offset:128
    v_mov_b32 v184, 0
    v_mov_b32 v185, 0
    v_mov_b32 v186, 0
    v_mov_b32 v187, 0
    v_mov_b32 v188, 0
    v_mov_b32 v189, 0
    s_waitcnt lgkmcnt(5)
    v_mfma_f32_32x32x16_bf16 v[80:95], v[52:55], v[116:119], v[80:95]
    ds_read_b128 v[52:55], v15 offset:128
    v_mov_b32 v190, 0
    v_mov_b32 v191, 0
    v_mov_b32 v192, 0
    v_mov_b32 v193, 0
    v_mov_b32 v194, 0
    v_mov_b32 v195, 0
    s_waitcnt lgkmcnt(5)
    v_mfma_f32_32x32x16_bf16 v[80:95], v[56:59], v[120:123], v[80:95]
    ds_read_b128 v[56:59], v12 offset:256
    v_mov_b32 v196, 0
    v_mov_b32 v197, 0
    v_mov_b32 v198, 0
    v_mov_b32 v199, 0
    v_mov_b32 v200, 0
    v_mov_b32 v201, 0
    s_waitcnt lgkmcnt(5)
    v_mfma_f32_32x32x16_bf16 v[80:95], v[60:63], v[124:127], v[80:95]
    ds_read_b128 v[60:63], v13 offset:256
    v_mov_b32 v202, 0
    v_mov_b32 v203, 0
    v_mov_b32 v204, 0
    v_mov_b32 v205, 0
    v_mov_b32 v206, 0
    v_mov_b32 v207, 0
    s_waitcnt lgkmcnt(5)
    v_mfma_f32_32x32x16_bf16 v[80:95], v[64:67], v[128:131], v[80:95]
    ds_read_b128 v[64:67], v14 offset:256
    v_mov_b32 v208, 0
    v_mov_b32 v209, 0
    v_mov_b32 v210, 0
    v_mov_b32 v211, 0
    v_mov_b32 v212, 0
    v_mov_b32 v213, 0
    s_waitcnt lgkmcnt(5)
    v_mfma_f32_32x32x16_bf16 v[80:95], v[68:71], v[132:135], v[80:95]
    ds_read_b128 v[68:71], v15 offset:256
    v_mov_b32 v214, 0
    v_mov_b32 v215, 0
    v_mov_b32 v216, 0
    v_mov_b32 v217, 0
    v_mov_b32 v218, 0
    v_mov_b32 v219, 0
    s_waitcnt lgkmcnt(5)
    v_mfma_f32_32x32x16_bf16 v[80:95], v[48:51], v[136:139], v[80:95]
    s_mov_b32 s33, s32
    s_add_u32 s32, s32, 24576
    s_cmp_eq_u32 s32, 122880
    s_cselect_b32 s32, 0, s32
    v_mov_b32 v220, 0
    v_mov_b32 v221, 0
    v_mov_b32 v222, 0
    v_mov_b32 v223, 0
    v_mov_b32 v224, 0
    v_mov_b32 v225, 0
    s_waitcnt lgkmcnt(4)
    v_mfma_f32_32x32x16_bf16 v[80:95], v[52:55], v[140:143], v[80:95]
    v_add_u32 v12, s32, v8
    v_xor_b32 v13, 32, v12
    v_xor_b32 v14, 64, v12
    v_xor_b32 v15, 96, v12
    v_mov_b32 v226, 0
    v_mov_b32 v227, 0
    v_mov_b32 v228, 0
    v_mov_b32 v229, 0
    v_mov_b32 v230, 0
    v_mov_b32 v231, 0
    s_waitcnt lgkmcnt(3)
    v_mfma_f32_32x32x16_bf16 v[80:95], v[56:59], v[144:147], v[80:95]
    v_mov_b32 v232, 0
    v_mov_b32 v233, 0
    v_mov_b32 v234, 0
    v_mov_b32 v235, 0
    v_mov_b32 v236, 0
    v_mov_b32 v237, 0
    s_waitcnt vmcnt(6) lgkmcnt(0)
    s_barrier
    ds_read_b128 v[48:51], v12 offset:0
    ds_read_b128 v[52:55], v13 offset:0
    ds_read_b128 v[56:59], v14 offset:0
    s_add_u32 m0, s34, 98304
    s_nop 0
    v_mfma_f32_32x32x16_bf16 v[80:95], v[60:63], v[148:151], v[80:95]
    v_mov_b32 v238, 0
    v_mov_b32 v239, 0
    v_mov_b32 v240, 0
    v_mov_b32 v241, 0
    v_mov_b32 v242, 0
    v_mov_b32 v243, 0
    ds_read_b128 v[60:63], v15 offset:0
    buffer_load_dwordx4 v16, s[12:15], s74 offen offset:0  lds
    buffer_load_dwordx4 v17, s[12:15], s74 offen offset:1024  lds
    v_mfma_f32_32x32x16_bf16 v[80:95], v[64:67], v[152:155], v[80:95]
    v_mov_b32 v244, 0
    v_mov_b32 v245, 0
    v_mov_b32 v246, 0
    v_mov_b32 v247, 0
    v_mov_b32 v248, 0
    v_mov_b32 v249, 0
    ds_read_b128 v[64:67], v12 offset:128
    buffer_load_dwordx4 v18, s[12:15], s74 offen offset:2048  lds
    s_add_u32 s74, s74, 12288
    s_cmp_eq_u32 s74, 196608
    s_cselect_b32 s74, 0, s74
    s_add_u32 m0, s33, s34
    s_nop 0
    buffer_load_dwordx4 v16, s[8:11], s40 offen offset:0  lds
    v_mfma_f32_32x32x16_bf16 v[80:95], v[68:71], v[156:159], v[80:95]
    v_mov_b32 v250, 0
    v_mov_b32 v251, 0
    v_mov_b32 v252, 0
    v_mov_b32 v253, 0
    v_mov_b32 v254, 0
    v_mov_b32 v255, 0
    ds_read_b128 v[68:71], v13 offset:128
    buffer_load_dwordx4 v17, s[8:11], s40 offen offset:1024  lds
    buffer_load_dwordx4 v18, s[8:11], s40 offen offset:2048  lds
    s_add_u32 s40, s40, 12288
    s_cmp_eq_u32 s40, 196608
    s_cselect_b32 s40, 0, s40
    s_waitcnt lgkmcnt(5)
    v_mfma_f32_32x32x16_bf16 v[96:111], v[48:51], v[112:115], 0
    ds_read_b128 v[48:51], v14 offset:128
    s_waitcnt lgkmcnt(5)
    v_mfma_f32_32x32x16_bf16 v[96:111], v[52:55], v[116:119], v[96:111]
    ds_read_b128 v[52:55], v15 offset:128
    s_waitcnt lgkmcnt(5)
    v_mfma_f32_32x32x16_bf16 v[96:111], v[56:59], v[120:123], v[96:111]
    ds_read_b128 v[56:59], v12 offset:256
    v_max3_f32 v40, v80, v81, v82
    v_max3_f32 v40, v40, v83, v84
    v_max3_f32 v40, v40, v85, v86
    v_max3_f32 v40, v40, v87, v88
    v_max3_f32 v40, v40, v89, v90
    v_max3_f32 v40, v40, v91, v92
    v_max3_f32 v40, v40, v93, v94
    s_waitcnt lgkmcnt(5)
    v_mfma_f32_32x32x16_bf16 v[96:111], v[60:63], v[124:127], v[96:111]
    ds_read_b128 v[60:63], v13 offset:256
    v_max_f32 v40, v40, v95
    v_mov_b32 v41, v40
    s_nop 1
    v_permlane32_swap_b32 v40, v41
    s_nop 1
    v_max_f32 v40, v40, v41
    v_mul_f32 v40, s42, v40
    v_cmp_gt_f32 vcc, v40, v37
    s_cbranch_vccnz L_ra1
L_rb1:
    s_nop 0
    v_fma_f32 v80, v80, s42, -v36
    v_fma_f32 v81, v81, s42, -v36
    s_waitcnt lgkmcnt(5)
    v_mfma_f32_32x32x16_bf16 v[96:111], v[64:67], v[128:131], v[96:111]
    ds_read_b128 v[64:67], v14 offset:256
    v_fma_f32 v82, v82, s42, -v36
    v_fma_f32 v83, v83, s42, -v36
    v_fma_f32 v84, v84, s42, -v36
    v_fma_f32 v85, v85, s42, -v36
    v_fma_f32 v86, v86, s42, -v36
    v_fma_f32 v87, v87, s42, -v36
    v_fma_f32 v88, v88, s42, -v36
    s_waitcnt lgkmcnt(5)
    v_mfma_f32_32x32x16_bf16 v[96:111], v[68:71], v[132:135], v[96:111]
    ds_read_b128 v[68:71], v15 offset:256
    v_fma_f32 v89, v89, s42, -v36
    v_fma_f32 v90, v90, s42, -v36
    v_fma_f32 v91, v91, s42, -v36
    v_fma_f32 v92, v92, s42, -v36
    v_fma_f32 v93, v93, s42, -v36
    v_fma_f32 v94, v94, s42, -v36
    v_fma_f32 v95, v95, s42, -v36
    s_waitcnt lgkmcnt(5)
    v_mfma_f32_32x32x16_bf16 v[96:111], v[48:51], v[136:139], v[96:111]
    s_mov_b32 s33, s32
    s_add_u32 s32, s32, 24576
    s_cmp_eq_u32 s32, 122880
    s_cselect_b32 s32, 0, s32
    v_exp_f32 v80, v80
    v_exp_f32 v81, v81
    v_exp_f32 v82, v82
    v_exp_f32 v83, v83
    v_exp_f32 v84, v84
    v_exp_f32 v85, v85
    s_waitcnt lgkmcnt(4)
    v_mfma_f32_32x32x16_bf16 v[96:111], v[52:55], v[140:143], v[96:111]
    v_add_u32 v12, s32, v9
    v_xor_b32 v13, 16, v12
    v_xor_b32 v14, 64, v12
    v_xor_b32 v15, 0x50, v12
    v_exp_f32 v86, v86
    v_exp_f32 v87, v87
    v_exp_f32 v88, v88
    v_exp_f32 v89, v89
    v_exp_f32 v90, v90
    v_exp_f32 v91, v91
    v_exp_f32 v92, v92
    s_waitcnt lgkmcnt(3)
    v_mfma_f32_32x32x16_bf16 v[96:111], v[56:59], v[144:147], v[96:111]
    v_exp_f32 v93, v93
    v_exp_f32 v94, v94
    v_exp_f32 v95, v95
    v_cvt_pk_bf16_f32 v72, v80, v81
    v_add_f32 v38, v38, v80
    v_add_f32 v39, v39, v81
    v_cvt_pk_bf16_f32 v73, v82, v83
    s_waitcnt vmcnt(9) lgkmcnt(0)
    s_barrier
    ds_read_b64_tr_b16 v[48:49], v12 offset:0
    ds_read_b64_tr_b16 v[50:51], v13 offset:1536
    ds_read_b64_tr_b16 v[52:53], v14 offset:0
    ds_read_b64_tr_b16 v[54:55], v15 offset:1536
    ds_read_b64_tr_b16 v[56:57], v12 offset:128
    ds_read_b64_tr_b16 v[58:59], v13 offset:1664
    s_add_u32 m0, s33, s34
    s_nop 0
    v_mfma_f32_32x32x16_bf16 v[96:111], v[60:63], v[148:151], v[96:111]
    v_add_f32 v38, v38, v82
    v_add_f32 v39, v39, v83
    v_cvt_pk_bf16_f32 v74, v84, v85
    v_add_f32 v38, v38, v84
    v_add_f32 v39, v39, v85
    v_cvt_pk_bf16_f32 v75, v86, v87
    v_add_f32 v38, v38, v86
    ds_read_b64_tr_b16 v[60:61], v14 offset:128
    ds_read_b64_tr_b16 v[62:63], v15 offset:1664
    buffer_load_dwordx4 v16, s[12:15], s74 offen offset:0  lds
    v_mfma_f32_32x32x16_bf16 v[96:111], v[64:67], v[152:155], v[96:111]
    v_add_f32 v39, v39, v87
    v_cvt_pk_bf16_f32 v76, v88, v89
    v_add_f32 v38, v38, v88
    v_add_f32 v39, v39, v89
    v_cvt_pk_bf16_f32 v77, v90, v91
    v_add_f32 v38, v38, v90
    v_add_f32 v39, v39, v91
    ds_read_b64_tr_b16 v[64:65], v12 offset:256
    ds_read_b64_tr_b16 v[66:67], v13 offset:1792
    buffer_load_dwordx4 v17, s[12:15], s74 offen offset:1024  lds
    v_mfma_f32_32x32x16_bf16 v[96:111], v[68:71], v[156:159], v[96:111]
    v_cvt_pk_bf16_f32 v78, v92, v93
    v_cvt_pk_bf16_f32 v79, v94, v95
    v_add_f32 v38, v38, v92
    v_add_f32 v39, v39, v93
    v_add_f32 v38, v38, v94
    v_add_f32 v39, v39, v95
    ds_read_b64_tr_b16 v[68:69], v14 offset:256
    ds_read_b64_tr_b16 v[70:71], v15 offset:1792
    buffer_load_dwordx4 v18, s[12:15], s74 offen offset:2048  lds
    s_add_u32 s74, s74, 12288
    s_cmp_eq_u32 s74, 196608
    s_cselect_b32 s74, 0, s74
    s_mov_b32 s38, 6
L_a:
    s_nop 0
    s_waitcnt lgkmcnt(10)
    v_mfma_f32_32x32x16_bf16 v[160:175], v[48:51], v[72:75], v[160:175]
    ds_read_b64_tr_b16 v[48:49], v12 offset:6144
    ds_read_b64_tr_b16 v[50:51], v13 offset:7680
    s_waitcnt lgkmcnt(10)
    v_mfma_f32_32x32x16_bf16 v[176:191], v[52:55], v[72:75], v[176:191]
    ds_read_b64_tr_b16 v[52:53], v14 offset:6144
    ds_read_b64_tr_b16 v[54:55], v15 offset:7680
    s_waitcnt lgkmcnt(10)
    v_mfma_f32_32x32x16_bf16 v[192:207], v[56:59], v[72:75], v[192:207]
    ds_read_b64_tr_b16 v[56:57], v12 offset:6272
    ds_read_b64_tr_b16 v[58:59], v13 offset:7808
    v_max3_f32 v40, v96, v97, v98
    v_max3_f32 v40, v40, v99, v100
    v_max3_f32 v40, v40, v101, v102
    v_max3_f32 v40, v40, v103, v104
    s_waitcnt lgkmcnt(10)
    v_mfma_f32_32x32x16_bf16 v[208:223], v[60:63], v[72:75], v[208:223]
    ds_read_b64_tr_b16 v[60:61], v14 offset:6272
    ds_read_b64_tr_b16 v[62:63], v15 offset:7808
    v_max3_f32 v40, v40, v105, v106
    v_max3_f32 v40, v40, v107, v108
    v_max3_f32 v40, v40, v109, v110
    v_max_f32 v40, v40, v111
    s_waitcnt lgkmcnt(10)
    v_mfma_f32_32x32x16_bf16 v[224:239], v[64:67], v[72:75], v[224:239]
    ds_read_b64_tr_b16 v[64:65], v12 offset:6400
    ds_read_b64_tr_b16 v[66:67], v13 offset:7936
    v_mov_b32 v41, v40
    s_nop 1
    v_permlane32_swap_b32 v40, v41
    s_nop 1
    v_max_f32 v40, v40, v41
    v_mul_f32 v40, s42, v40
    s_waitcnt lgkmcnt(10)
    v_mfma_f32_32x32x16_bf16 v[240:255], v[68:71], v[72:75], v[240:255]
    ds_read_b64_tr_b16 v[68:69], v14 offset:6400
    ds_read_b64_tr_b16 v[70:71], v15 offset:7936
    v_cmp_gt_f32 vcc, v40, v37
    s_cbranch_vccnz L_ra2
L_rb2:
    s_nop 0
    v_fma_f32 v96, v96, s42, -v36
    v_fma_f32 v97, v97, s42, -v36
    v_fma_f32 v98, v98, s42, -v36
    s_waitcnt lgkmcnt(10)
    v_mfma_f32_32x32x16_bf16 v[160:175], v[48:51], v[76:79], v[160:175]
    s_mov_b32 s33, s32
    s_add_u32 s32, s32, 24576
    s_cmp_eq_u32 s32, 122880
    s_cselect_b32 s32, 0, s32
    v_fma_f32 v99, v99, s42, -v36
    v_fma_f32 v100, v100, s42, -v36
    v_fma_f32 v101, v101, s42, -v36
    s_waitcnt lgkmcnt(8)
    v_mfma_f32_32x32x16_bf16 v[176:191], v[52:55], v[76:79], v[176:191]
    v_add_u32 v12, s32, v8
    v_xor_b32 v13, 32, v12
    v_xor_b32 v14, 64, v12
    v_xor_b32 v15, 96, v12
    v_fma_f32 v102, v102, s42, -v36
    v_fma_f32 v103, v103, s42, -v36
    v_fma_f32 v104, v104, s42, -v36
    v_fma_f32 v105, v105, s42, -v36
    s_waitcnt lgkmcnt(6)
    v_mfma_f32_32x32x16_bf16 v[192:207], v[56:59], v[76:79], v[192:207]
    v_fma_f32 v106, v106, s42, -v36
    v_fma_f32 v107, v107, s42, -v36
    v_fma_f32 v108, v108, s42, -v36
    v_fma_f32 v109, v109, s42, -v36
    s_waitcnt vmcnt(9) lgkmcnt(0)
    s_barrier
    ds_read_b128 v[48:51], v12 offset:0
    ds_read_b128 v[52:55], v13 offset:0
    ds_read_b128 v[56:59], v14 offset:0
    s_add_u32 m0, s33, s34
    s_nop 0
    v_mfma_f32_32x32x16_bf16 v[208:223], v[60:63], v[76:79], v[208:223]
    v_fma_f32 v110, v110, s42, -v36
    v_fma_f32 v111, v111, s42, -v36
    v_exp_f32 v96, v96
    ds_read_b128 v[60:63], v15 offset:0
    buffer_load_dwordx4 v16, s[8:11], s40 offen offset:0  lds
    v_mfma_f32_32x32x16_bf16 v[224:239], v[64:67], v[76:79], v[224:239]
    v_exp_f32 v97, v97
    v_exp_f32 v98, v98
    v_exp_f32 v99, v99
    v_exp_f32 v100, v100
    ds_read_b128 v[64:67], v12 offset:128
    buffer_load_dwordx4 v17, s[8:11], s40 offen offset:1024  lds
    v_mfma_f32_32x32x16_bf16 v[240:255], v[68:71], v[76:79], v[240:255]
    v_exp_f32 v101, v101
    v_exp_f32 v102, v102
    v_exp_f32 v103, v103
    ds_read_b128 v[68:71], v13 offset:128
    buffer_load_dwordx4 v18, s[8:11], s40 offen offset:2048  lds
    s_add_u32 s40, s40, 12288
    s_cmp_eq_u32 s40, 196608
    s_cselect_b32 s40, 0, s40
    s_waitcnt lgkmcnt(5)
    v_mfma_f32_32x32x16_bf16 v[80:95], v[48:51], v[112:115], 0
    ds_read_b128 v[48:51], v14 offset:128
    v_exp_f32 v104, v104
    v_exp_f32 v105, v105
    v_exp_f32 v106, v106
    s_waitcnt lgkmcnt(5)
    v_mfma_f32_32x32x16_bf16 v[80:95], v[52:55], v[116:119], v[80:95]
    ds_read_b128 v[52:55], v15 offset:128
    v_exp_f32 v107, v107
    v_exp_f32 v108, v108
    v_exp_f32 v109, v109
    s_waitcnt lgkmcnt(5)
    v_mfma_f32_32x32x16_bf16 v[80:95], v[56:59], v[120:123], v[80:95]
    ds_read_b128 v[56:59], v12 offset:256
    s_cmp_lg_u32 s75, 0
    s_cbranch_scc1 L_ra3
L_rb3:
    s_nop 0
    v_exp_f32 v110, v110
    v_exp_f32 v111, v111
    s_waitcnt lgkmcnt(5)
    v_mfma_f32_32x32x16_bf16 v[80:95], v[60:63], v[124:127], v[80:95]
    ds_read_b128 v[60:63], v13 offset:256
    v_cvt_pk_bf16_f32 v72, v96, v97
    v_add_f32 v38, v38, v96
    v_add_f32 v39, v39, v97
    s_waitcnt lgkmcnt(5)
    v_mfma_f32_32x32x16_bf16 v[80:95], v[64:67], v[128:131], v[80:95]
    ds_read_b128 v[64:67], v14 offset:256
    v_cvt_pk_bf16_f32 v73, v98, v99
    v_add_f32 v38, v38, v98
    v_add_f32 v39, v39, v99
    s_waitcnt lgkmcnt(5)
    v_mfma_f32_32x32x16_bf16 v[80:95], v[68:71], v[132:135], v[80:95]
    ds_read_b128 v[68:71], v15 offset:256
    v_cvt_pk_bf16_f32 v74, v100, v101
    v_add_f32 v38, v38, v100
    s_waitcnt lgkmcnt(5)
    v_mfma_f32_32x32x16_bf16 v[80:95], v[48:51], v[136:139], v[80:95]
    s_mov_b32 s33, s32
    s_add_u32 s32, s32, 24576
    s_cmp_eq_u32 s32, 122880
    s_cselect_b32 s32, 0, s32
    v_add_f32 v39, v39, v101
    v_cvt_pk_bf16_f32 v75, v102, v103
    v_add_f32 v38, v38, v102
    s_waitcnt lgkmcnt(4)
    v_mfma_f32_32x32x16_bf16 v[80:95], v[52:55], v[140:143], v[80:95]
    v_add_u32 v12, s32, v9
    v_xor_b32 v13, 16, v12
    v_xor_b32 v14, 64, v12
    v_xor_b32 v15, 0x50, v12
    v_add_f32 v39, v39, v103
    v_cvt_pk_bf16_f32 v76, v104, v105
    v_add_f32 v38, v38, v104
    s_waitcnt lgkmcnt(3)
    v_mfma_f32_32x32x16_bf16 v[80:95], v[56:59], v[144:147], v[80:95]
    v_add_f32 v39, v39, v105
    v_cvt_pk_bf16_f32 v77, v106, v107
    s_waitcnt vmcnt(9) lgkmcnt(0)
    s_barrier
    ds_read_b64_tr_b16 v[48:49], v12 offset:0
    ds_read_b64_tr_b16 v[50:51], v13 offset:1536
    ds_read_b64_tr_b16 v[52:53], v14 offset:0
    ds_read_b64_tr_b16 v[54:55], v15 offset:1536
    ds_read_b64_tr_b16 v[56:57], v12 offset:128
    ds_read_b64_tr_b16 v[58:59], v13 offset:1664
    s_add_u32 m0, s33, s34
    s_nop 0
    v_mfma_f32_32x32x16_bf16 v[80:95], v[60:63], v[148:151], v[80:95]
    v_add_f32 v38, v38, v106
    v_add_f32 v39, v39, v107
    v_cvt_pk_bf16_f32 v78, v108, v109
    ds_read_b64_tr_b16 v[60:61], v14 offset:128
    ds_read_b64_tr_b16 v[62:63], v15 offset:1664
    buffer_load_dwordx4 v16, s[12:15], s74 offen offset:0  lds
    v_mfma_f32_32x32x16_bf16 v[80:95], v[64:67], v[152:155], v[80:95]
    v_cvt_pk_bf16_f32 v79, v110, v111
    v_add_f32 v38, v38, v108
    v_add_f32 v39, v39, v109
    ds_read_b64_tr_b16 v[64:65], v12 offset:256
    ds_read_b64_tr_b16 v[66:67], v13 offset:1792
    buffer_load_dwordx4 v17, s[12:15], s74 offen offset:1024  lds
    v_mfma_f32_32x32x16_bf16 v[80:95], v[68:71], v[156:159], v[80:95]
    v_add_f32 v38, v38, v110
    v_add_f32 v39, v39, v111
    ds_read_b64_tr_b16 v[68:69], v14 offset:256
    ds_read_b64_tr_b16 v[70:71], v15 offset:1792
    buffer_load_dwordx4 v18, s[12:15], s74 offen offset:2048  lds
    s_add_u32 s74, s74, 12288
    s_cmp_eq_u32 s74, 196608
    s_cselect_b32 s74, 0, s74
    s_nop 0
    s_waitcnt lgkmcnt(10)
    v_mfma_f32_32x32x16_bf16 v[160:175], v[48:51], v[72:75], v[160:175]
    ds_read_b64_tr_b16 v[48:49], v12 offset:6144
    ds_read_b64_tr_b16 v[50:51], v13 offset:7680
    s_waitcnt lgkmcnt(10)
    v_mfma_f32_32x32x16_bf16 v[176:191], v[52:55], v[72:75], v[176:191]
    ds_read_b64_tr_b16 v[52:53], v14 offset:6144
    ds_read_b64_tr_b16 v[54:55], v15 offset:7680
    s_waitcnt lgkmcnt(10)
    v_mfma_f32_32x32x16_bf16 v[192:207], v[56:59], v[72:75], v[192:207]
    ds_read_b64_tr_b16 v[56:57], v12 offset:6272
    ds_read_b64_tr_b16 v[58:59], v13 offset:7808
    v_max3_f32 v40, v80, v81, v82
    v_max3_f32 v40, v40, v83, v84
    v_max3_f32 v40, v40, v85, v86
    v_max3_f32 v40, v40, v87, v88
    s_waitcnt lgkmcnt(10)
    v_mfma_f32_32x32x16_bf16 v[208:223], v[60:63], v[72:75], v[208:223]
    ds_read_b64_tr_b16 v[60:61], v14 offset:6272
    ds_read_b64_tr_b16 v[62:63], v15 offset:7808
    v_max3_f32 v40, v40, v89, v90
    v_max3_f32 v40, v40, v91, v92
    v_max3_f32 v40, v40, v93, v94
    v_max_f32 v40, v40, v95
    s_waitcnt lgkmcnt(10)
    v_mfma_f32_32x32x16_bf16 v[224:239], v[64:67], v[72:75], v[224:239]
    ds_read_b64_tr_b16 v[64:65], v12 offset:6400
    ds_read_b64_tr_b16 v[66:67], v13 offset:7936
    v_mov_b32 v41, v40
    s_nop 1
    v_permlane32_swap_b32 v40, v41
    s_nop 1
    v_max_f32 v40, v40, v41
    v_mul_f32 v40, s42, v40
    s_waitcnt lgkmcnt(10)
    v_mfma_f32_32x32x16_bf16 v[240:255], v[68:71], v[72:75], v[240:255]
    ds_read_b64_tr_b16 v[68:69], v14 offset:6400
    ds_read_b64_tr_b16 v[70:71], v15 offset:7936
    v_cmp_gt_f32 vcc, v40, v37
    s_cbranch_vccnz L_ra4
L_rb4:
    s_nop 0
    v_fma_f32 v80, v80, s42, -v36
    v_fma_f32 v81, v81, s42, -v36
    v_fma_f32 v82, v82, s42, -v36
    s_waitcnt lgkmcnt(10)
    v_mfma_f32_32x32x16_bf16 v[160:175], v[48:51], v[76:79], v[160:175]
    s_mov_b32 s33, s32
    s_add_u32 s32, s32, 24576
    s_cmp_eq_u32 s32, 122880
    s_cselect_b32 s32, 0, s32
    v_fma_f32 v83, v83, s42, -v36
    v_fma_f32 v84, v84, s42, -v36
    v_fma_f32 v85, v85, s42, -v36
    s_waitcnt lgkmcnt(8)
    v_mfma_f32_32x32x16_bf16 v[176:191], v[52:55], v[76:79], v[176:191]
    v_add_u32 v12, s32, v8
    v_xor_b32 v13, 32, v12
    v_xor_b32 v14, 64, v12
    v_xor_b32 v15, 96, v12
    v_fma_f32 v86, v86, s42, -v36
    v_fma_f32 v87, v87, s42, -v36
    v_fma_f32 v88, v88, s42, -v36
    v_fma_f32 v89, v89, s42, -v36
    s_waitcnt lgkmcnt(6)
    v_mfma_f32_32x32x16_bf16 v[192:207], v[56:59], v[76:79], v[192:207]
    v_fma_f32 v90, v90, s42, -v36
    v_fma_f32 v91, v91, s42, -v36
    v_fma_f32 v92, v92, s42, -v36
    v_fma_f32 v93, v93, s42, -v36
    s_waitcnt vmcnt(9) lgkmcnt(0)
    s_barrier
    ds_read_b128 v[48:51], v12 offset:0
    ds_read_b128 v[52:55], v13 offset:0
    ds_read_b128 v[56:59], v14 offset:0
    s_add_u32 m0, s33, s34
    s_nop 0
    v_mfma_f32_32x32x16_bf16 v[208:223], v[60:63], v[76:79], v[208:223]
    v_fma_f32 v94, v94, s42, -v36
    v_fma_f32 v95, v95, s42, -v36
    v_exp_f32 v80, v80
    ds_read_b128 v[60:63], v15 offset:0
    buffer_load_dwordx4 v16, s[8:11], s40 offen offset:0  lds
    v_mfma_f32_32x32x16_bf16 v[224:239], v[64:67], v[76:79], v[224:239]
    v_exp_f32 v81, v81
    v_exp_f32 v82, v82
    v_exp_f32 v83, v83
    v_exp_f32 v84, v84
    ds_read_b128 v[64:67], v12 offset:128
    buffer_load_dwordx4 v17, s[8:11], s40 offen offset:1024  lds
    v_mfma_f32_32x32x16_bf16 v[240:255], v[68:71], v[76:79], v[240:255]
    v_exp_f32 v85, v85
    v_exp_f32 v86, v86
    v_exp_f32 v87, v87
    ds_read_b128 v[68:71], v13 offset:128
    buffer_load_dwordx4 v18, s[8:11], s40 offen offset:2048  lds
    s_add_u32 s40, s40, 12288
    s_cmp_eq_u32 s40, 196608
    s_cselect_b32 s40, 0, s40
    s_waitcnt lgkmcnt(5)
    v_mfma_f32_32x32x16_bf16 v[96:111], v[48:51], v[112:115], 0
    ds_read_b128 v[48:51], v14 offset:128
    v_exp_f32 v88, v88
    v_exp_f32 v89, v89
    v_exp_f32 v90, v90
    s_waitcnt lgkmcnt(5)
    v_mfma_f32_32x32x16_bf16 v[96:111], v[52:55], v[116:119], v[96:111]
    ds_read_b128 v[52:55], v15 offset:128
    v_exp_f32 v91, v91
    v_exp_f32 v92, v92
    v_exp_f32 v93, v93
    s_waitcnt lgkmcnt(5)
    v_mfma_f32_32x32x16_bf16 v[96:111], v[56:59], v[120:123], v[96:111]
    ds_read_b128 v[56:59], v12 offset:256
    s_cmp_lg_u32 s75, 0
    s_cbranch_scc1 L_ra5
L_rb5:
    s_nop 0
    v_exp_f32 v94, v94
    v_exp_f32 v95, v95
    s_waitcnt lgkmcnt(5)
    v_mfma_f32_32x32x16_bf16 v[96:111], v[60:63], v[124:127], v[96:111]
    ds_read_b128 v[60:63], v13 offset:256
    v_cvt_pk_bf16_f32 v72, v80, v81
    v_add_f32 v38, v38, v80
    v_add_f32 v39, v39, v81
    s_waitcnt lgkmcnt(5)
    v_mfma_f32_32x32x16_bf16 v[96:111], v[64:67], v[128:131], v[96:111]
    ds_read_b128 v[64:67], v14 offset:256
    v_cvt_pk_bf16_f32 v73, v82, v83
    v_add_f32 v38, v38, v82
    v_add_f32 v39, v39, v83
    s_waitcnt lgkmcnt(5)
    v_mfma_f32_32x32x16_bf16 v[96:111], v[68:71], v[132:135], v[96:111]
    ds_read_b128 v[68:71], v15 offset:256
    v_cvt_pk_bf16_f32 v74, v84, v85
    v_add_f32 v38, v38, v84
    s_waitcnt lgkmcnt(5)
    v_mfma_f32_32x32x16_bf16 v[96:111], v[48:51], v[136:139], v[96:111]
    s_mov_b32 s33, s32
    s_add_u32 s32, s32, 24576
    s_cmp_eq_u32 s32, 122880
    s_cselect_b32 s32, 0, s32
    v_add_f32 v39, v39, v85
    v_cvt_pk_bf16_f32 v75, v86, v87
    v_add_f32 v38, v38, v86
    s_waitcnt lgkmcnt(4)
    v_mfma_f32_32x32x16_bf16 v[96:111], v[52:55], v[140:143], v[96:111]
    v_add_u32 v12, s32, v9
    v_xor_b32 v13, 16, v12
    v_xor_b32 v14, 64, v12
    v_xor_b32 v15, 0x50, v12
    v_add_f32 v39, v39, v87
    v_cvt_pk_bf16_f32 v76, v88, v89
    v_add_f32 v38, v38, v88
    s_waitcnt lgkmcnt(3)
    v_mfma_f32_32x32x16_bf16 v[96:111], v[56:59], v[144:147], v[96:111]
    v_add_f32 v39, v39, v89
    v_cvt_pk_bf16_f32 v77, v90, v91
    s_waitcnt vmcnt(9) lgkmcnt(0)
    s_barrier
    ds_read_b64_tr_b16 v[48:49], v12 offset:0
    ds_read_b64_tr_b16 v[50:51], v13 offset:1536
    ds_read_b64_tr_b16 v[52:53], v14 offset:0
    ds_read_b64_tr_b16 v[54:55], v15 offset:1536
    ds_read_b64_tr_b16 v[56:57], v12 offset:128
    ds_read_b64_tr_b16 v[58:59], v13 offset:1664
    s_add_u32 m0, s33, s34
    s_nop 0
    v_mfma_f32_32x32x16_bf16 v[96:111], v[60:63], v[148:151], v[96:111]
    v_add_f32 v38, v38, v90
    v_add_f32 v39, v39, v91
    v_cvt_pk_bf16_f32 v78, v92, v93
    ds_read_b64_tr_b16 v[60:61], v14 offset:128
    ds_read_b64_tr_b16 v[62:63], v15 offset:1664
    buffer_load_dwordx4 v16, s[12:15], s74 offen offset:0  lds
    v_mfma_f32_32x32x16_bf16 v[96:111], v[64:67], v[152:155], v[96:111]
    v_cvt_pk_bf16_f32 v79, v94, v95
    v_add_f32 v38, v38, v92
    v_add_f32 v39, v39, v93
    ds_read_b64_tr_b16 v[64:65], v12 offset:256
    ds_read_b64_tr_b16 v[66:67], v13 offset:1792
    buffer_load_dwordx4 v17, s[12:15], s74 offen offset:1024  lds
    v_mfma_f32_32x32x16_bf16 v[96:111], v[68:71], v[156:159], v[96:111]
    v_add_f32 v38, v38, v94
    v_add_f32 v39, v39, v95
    ds_read_b64_tr_b16 v[68:69], v14 offset:256
    ds_read_b64_tr_b16 v[70:71], v15 offset:1792
    buffer_load_dwordx4 v18, s[12:15], s74 offen offset:2048  lds
    s_add_u32 s74, s74, 12288
    s_cmp_eq_u32 s74, 196608
    s_cselect_b32 s74, 0, s74
    s_sub_u32 s38, s38, 1
    s_cmp_lg_u32 s38, 0
    s_cbranch_scc1 L_a
    s_nop 0
    s_waitcnt lgkmcnt(10)
    v_mfma_f32_32x32x16_bf16 v[160:175], v[48:51], v[72:75], v[160:175]
    ds_read_b64_tr_b16 v[48:49], v12 offset:6144
    ds_read_b64_tr_b16 v[50:51], v13 offset:7680
    s_waitcnt lgkmcnt(10)
    v_mfma_f32_32x32x16_bf16 v[176:191], v[52:55], v[72:75], v[176:191]
    ds_read_b64_tr_b16 v[52:53], v14 offset:6144
    ds_read_b64_tr_b16 v[54:55], v15 offset:7680
    s_waitcnt lgkmcnt(10)
    v_mfma_f32_32x32x16_bf16 v[192:207], v[56:59], v[72:75], v[192:207]
    ds_read_b64_tr_b16 v[56:57], v12 offset:6272
    ds_read_b64_tr_b16 v[58:59], v13 offset:7808
    v_max3_f32 v40, v96, v97, v98
    v_max3_f32 v40, v40, v99, v100
    v_max3_f32 v40, v40, v101, v102
    v_max3_f32 v40, v40, v103, v104
    s_waitcnt lgkmcnt(10)
    v_mfma_f32_32x32x16_bf16 v[208:223], v[60:63], v[72:75], v[208:223]
    ds_read_b64_tr_b16 v[60:61], v14 offset:6272
    ds_read_b64_tr_b16 v[62:63], v15 offset:7808
    v_max3_f32 v40, v40, v105, v106
    v_max3_f32 v40, v40, v107, v108
    v_max3_f32 v40, v40, v109, v110
    v_max_f32 v40, v40, v111
    s_waitcnt lgkmcnt(10)
    v_mfma_f32_32x32x16_bf16 v[224:239], v[64:67], v[72:75], v[224:239]
    ds_read_b64_tr_b16 v[64:65], v12 offset:6400
    ds_read_b64_tr_b16 v[66:67], v13 offset:7936
    v_mov_b32 v41, v40
    s_nop 1
    v_permlane32_swap_b32 v40, v41
    s_nop 1
    v_max_f32 v40, v40, v41
    v_mul_f32 v40, s42, v40
    s_waitcnt lgkmcnt(10)
    v_mfma_f32_32x32x16_bf16 v[240:255], v[68:71], v[72:75], v[240:255]
    ds_read_b64_tr_b16 v[68:69], v14 offset:6400
    ds_read_b64_tr_b16 v[70:71], v15 offset:7936
    v_cmp_gt_f32 vcc, v40, v37
    s_cbranch_vccnz L_ra6
L_rb6:
    s_nop 0
    v_fma_f32 v96, v96, s42, -v36
    v_fma_f32 v97, v97, s42, -v36
    v_fma_f32 v98, v98, s42, -v36
    s_waitcnt lgkmcnt(10)
    v_mfma_f32_32x32x16_bf16 v[160:175], v[48:51], v[76:79], v[160:175]
    s_mov_b32 s33, s32
    s_add_u32 s32, s32, 24576
    s_cmp_eq_u32 s32, 122880
    s_cselect_b32 s32, 0, s32
    v_fma_f32 v99, v99, s42, -v36
    v_fma_f32 v100, v100, s42, -v36
    v_fma_f32 v101, v101, s42, -v36
    s_waitcnt lgkmcnt(8)
    v_mfma_f32_32x32x16_bf16 v[176:191], v[52:55], v[76:79], v[176:191]
    v_add_u32 v12, s32, v8
    v_xor_b32 v13, 32, v12
    v_xor_b32 v14, 64, v12
    v_xor_b32 v15, 96, v12
    v_fma_f32 v102, v102, s42, -v36
    v_fma_f32 v103, v103, s42, -v36
    v_fma_f32 v104, v104, s42, -v36
    v_fma_f32 v105, v105, s42, -v36
    s_waitcnt lgkmcnt(6)
    v_mfma_f32_32x32x16_bf16 v[192:207], v[56:59], v[76:79], v[192:207]
    v_fma_f32 v106, v106, s42, -v36
    v_fma_f32 v107, v107, s42, -v36
    v_fma_f32 v108, v108, s42, -v36
    v_fma_f32 v109, v109, s42, -v36
    s_waitcnt vmcnt(9) lgkmcnt(0)
    s_barrier
    ds_read_b128 v[48:51], v12 offset:0
    ds_read_b128 v[52:55], v13 offset:0
    ds_read_b128 v[56:59], v14 offset:0
    s_add_u32 m0, s33, s34
    s_nop 0
    v_mfma_f32_32x32x16_bf16 v[208:223], v[60:63], v[76:79], v[208:223]
    v_fma_f32 v110, v110, s42, -v36
    v_fma_f32 v111, v111, s42, -v36
    v_exp_f32 v96, v96
    ds_read_b128 v[60:63], v15 offset:0
    buffer_load_dwordx4 v16, s[12:15], s74 offen offset:0  lds
    buffer_load_dwordx4 v17, s[12:15], s74 offen offset:1024  lds
    v_mfma_f32_32x32x16_bf16 v[224:239], v[64:67], v[76:79], v[224:239]
    v_exp_f32 v97, v97
    v_exp_f32 v98, v98
    v_exp_f32 v99, v99
    v_exp_f32 v100, v100
    ds_read_b128 v[64:67], v12 offset:128
    buffer_load_dwordx4 v18, s[12:15], s74 offen offset:2048  lds
    s_add_u32 s74, s74, 12288
    s_cmp_eq_u32 s74, 196608
    s_cselect_b32 s74, 0, s74
    s_mul_i32 s43, s77, 61440
    v_mfma_f32_32x32x16_bf16 v[240:255], v[68:71], v[76:79], v[240:255]
    v_exp_f32 v101, v101
    v_exp_f32 v102, v102
    v_exp_f32 v103, v103
    ds_read_b128 v[68:71], v13 offset:128
    buffer_load_dword v46, v47, s[20:23], s43 offen
    s_waitcnt lgkmcnt(5)
    v_mfma_f32_32x32x16_bf16 v[80:95], v[48:51], v[112:115], 0
    ds_read_b128 v[48:51], v14 offset:128
    v_exp_f32 v104, v104
    v_exp_f32 v105, v105
    v_exp_f32 v106, v106
    s_waitcnt lgkmcnt(5)
    v_mfma_f32_32x32x16_bf16 v[80:95], v[52:55], v[116:119], v[80:95]
    ds_read_b128 v[52:55], v15 offset:128
    v_exp_f32 v107, v107
    v_exp_f32 v108, v108
    v_exp_f32 v109, v109
    s_waitcnt lgkmcnt(5)
    v_mfma_f32_32x32x16_bf16 v[80:95], v[56:59], v[120:123], v[80:95]
    ds_read_b128 v[56:59], v12 offset:256
    s_cmp_lg_u32 s75, 0
    s_cbranch_scc1 L_ra7
L_rb7:
    s_nop 0
    v_exp_f32 v110, v110
    v_exp_f32 v111, v111
    s_waitcnt lgkmcnt(5)
    v_mfma_f32_32x32x16_bf16 v[80:95], v[60:63], v[124:127], v[80:95]
    ds_read_b128 v[60:63], v13 offset:256
    v_cvt_pk_bf16_f32 v72, v96, v97
    v_add_f32 v38, v38, v96
    v_add_f32 v39, v39, v97
    s_waitcnt lgkmcnt(5)
    v_mfma_f32_32x32x16_bf16 v[80:95], v[64:67], v[128:131], v[80:95]
    ds_read_b128 v[64:67], v14 offset:256
    v_cvt_pk_bf16_f32 v73, v98, v99
    v_add_f32 v38, v38, v98
    v_add_f32 v39, v39, v99
    s_waitcnt lgkmcnt(5)
    v_mfma_f32_32x32x16_bf16 v[80:95], v[68:71], v[132:135], v[80:95]
    ds_read_b128 v[68:71], v15 offset:256
    v_cvt_pk_bf16_f32 v74, v100, v101
    v_add_f32 v38, v38, v100
    s_waitcnt lgkmcnt(5)
    v_mfma_f32_32x32x16_bf16 v[80:95], v[48:51], v[136:139], v[80:95]
    s_mov_b32 s33, s32
    s_add_u32 s32, s32, 24576
    s_cmp_eq_u32 s32, 122880
    s_cselect_b32 s32, 0, s32
    v_add_f32 v39, v39, v101
    v_cvt_pk_bf16_f32 v75, v102, v103
    v_add_f32 v38, v38, v102
    s_waitcnt lgkmcnt(4)
    v_mfma_f32_32x32x16_bf16 v[80:95], v[52:55], v[140:143], v[80:95]
    v_add_u32 v12, s32, v9
    v_xor_b32 v13, 16, v12
    v_xor_b32 v14, 64, v12
    v_xor_b32 v15, 0x50, v12
    v_add_f32 v39, v39, v103
    v_cvt_pk_bf16_f32 v76, v104, v105
    v_add_f32 v38, v38, v104
    s_waitcnt lgkmcnt(3)
    v_mfma_f32_32x32x16_bf16 v[80:95], v[56:59], v[144:147], v[80:95]
    v_add_f32 v39, v39, v105
    v_cvt_pk_bf16_f32 v77, v106, v107
    s_waitcnt vmcnt(10) lgkmcnt(0)
    s_barrier
    ds_read_b64_tr_b16 v[48:49], v12 offset:0
    ds_read_b64_tr_b16 v[50:51], v13 offset:1536
    ds_read_b64_tr_b16 v[52:53], v14 offset:0
    ds_read_b64_tr_b16 v[54:55], v15 offset:1536
    ds_read_b64_tr_b16 v[56:57], v12 offset:128
    ds_read_b64_tr_b16 v[58:59], v13 offset:1664
    s_add_u32 m0, s33, s34
    s_nop 0
    v_mfma_f32_32x32x16_bf16 v[80:95], v[60:63], v[148:151], v[80:95]
    v_add_f32 v38, v38, v106
    v_add_f32 v39, v39, v107
    v_cvt_pk_bf16_f32 v78, v108, v109
    ds_read_b64_tr_b16 v[60:61], v14 offset:128
    ds_read_b64_tr_b16 v[62:63], v15 offset:1664
    buffer_load_dwordx4 v24, s[20:23], s39 offen offset:0  lds
    v_mfma_f32_32x32x16_bf16 v[80:95], v[64:67], v[152:155], v[80:95]
    v_cvt_pk_bf16_f32 v79, v110, v111
    v_add_f32 v38, v38, v108
    v_add_f32 v39, v39, v109
    ds_read_b64_tr_b16 v[64:65], v12 offset:256
    ds_read_b64_tr_b16 v[66:67], v13 offset:1792
    buffer_load_dwordx4 v25, s[20:23], s39 offen offset:1024  lds
    v_mfma_f32_32x32x16_bf16 v[80:95], v[68:71], v[156:159], v[80:95]
    v_add_f32 v38, v38, v110
    v_add_f32 v39, v39, v111
    ds_read_b64_tr_b16 v[68:69], v14 offset:256
    ds_read_b64_tr_b16 v[70:71], v15 offset:1792
    buffer_load_dwordx4 v26, s[20:23], s39 offen offset:2048  lds
    s_add_u32 s39, s39, 122880
    s_nop 0
    s_waitcnt lgkmcnt(10)
    v_mfma_f32_32x32x16_bf16 v[160:175], v[48:51], v[72:75], v[160:175]
    ds_read_b64_tr_b16 v[48:49], v12 offset:6144
    ds_read_b64_tr_b16 v[50:51], v13 offset:7680
    s_waitcnt lgkmcnt(10)
    v_mfma_f32_32x32x16_bf16 v[176:191], v[52:55], v[72:75], v[176:191]
    ds_read_b64_tr_b16 v[52:53], v14 offset:6144
    ds_read_b64_tr_b16 v[54:55], v15 offset:7680
    s_waitcnt lgkmcnt(10)
    v_mfma_f32_32x32x16_bf16 v[192:207], v[56:59], v[72:75], v[192:207]
    ds_read_b64_tr_b16 v[56:57], v12 offset:6272
    ds_read_b64_tr_b16 v[58:59], v13 offset:7808
    v_max3_f32 v40, v80, v81, v82
    v_max3_f32 v40, v40, v83, v84
    v_max3_f32 v40, v40, v85, v86
    v_max3_f32 v40, v40, v87, v88
    s_waitcnt lgkmcnt(10)
    v_mfma_f32_32x32x16_bf16 v[208:223], v[60:63], v[72:75], v[208:223]
    ds_read_b64_tr_b16 v[60:61], v14 offset:6272
    ds_read_b64_tr_b16 v[62:63], v15 offset:7808
    v_max3_f32 v40, v40, v89, v90
    v_max3_f32 v40, v40, v91, v92
    v_max3_f32 v40, v40, v93, v94
    v_max_f32 v40, v40, v95
    s_waitcnt lgkmcnt(10)
    v_mfma_f32_32x32x16_bf16 v[224:239], v[64:67], v[72:75], v[224:239]
    ds_read_b64_tr_b16 v[64:65], v12 offset:6400
    ds_read_b64_tr_b16 v[66:67], v13 offset:7936
    v_mov_b32 v41, v40
    s_nop 1
    v_permlane32_swap_b32 v40, v41
    s_nop 1
    v_max_f32 v40, v40, v41
    v_mul_f32 v40, s42, v40
    s_waitcnt lgkmcnt(10)
    v_mfma_f32_32x32x16_bf16 v[240:255], v[68:71], v[72:75], v[240:255]
    ds_read_b64_tr_b16 v[68:69], v14 offset:6400
    ds_read_b64_tr_b16 v[70:71], v15 offset:7936
    v_cmp_gt_f32 vcc, v40, v37
    s_cbranch_vccnz L_ra8
L_rb8:
    s_nop 0
    v_fma_f32 v80, v80, s42, -v36
    v_fma_f32 v81, v81, s42, -v36
    v_fma_f32 v82, v82, s42, -v36
    s_waitcnt lgkmcnt(10)
    v_mfma_f32_32x32x16_bf16 v[160:175], v[48:51], v[76:79], v[160:175]
    s_mov_b32 s33, s32
    s_add_u32 s32, s32, 24576
    s_cmp_eq_u32 s32, 122880
    s_cselect_b32 s32, 0, s32
    v_fma_f32 v83, v83, s42, -v36
    v_fma_f32 v84, v84, s42, -v36
    v_fma_f32 v85, v85, s42, -v36
    s_waitcnt lgkmcnt(8)
    v_mfma_f32_32x32x16_bf16 v[176:191], v[52:55], v[76:79], v[176:191]
    v_add_u32 v12, s32, v8
    v_xor_b32 v13, 32, v12
    v_xor_b32 v14, 64, v12
    v_xor_b32 v15, 96, v12
    v_fma_f32 v86, v86, s42, -v36
    v_fma_f32 v87, v87, s42, -v36
    v_fma_f32 v88, v88, s42, -v36
    v_fma_f32 v89, v89, s42, -v36
    s_waitcnt lgkmcnt(6)
    v_mfma_f32_32x32x16_bf16 v[192:207], v[56:59], v[76:79], v[192:207]
    v_fma_f32 v90, v90, s42, -v36
    v_fma_f32 v91, v91, s42, -v36
    v_fma_f32 v92, v92, s42, -v36
    v_fma_f32 v93, v93, s42, -v36
    s_waitcnt vmcnt(10) lgkmcnt(0)
    s_barrier
    ds_read_b128 v[48:51], v12 offset:0
    ds_read_b128 v[52:55], v13 offset:0
    ds_read_b128 v[56:59], v14 offset:0
    s_add_u32 m0, s33, s34
    s_nop 0
    v_mfma_f32_32x32x16_bf16 v[208:223], v[60:63], v[76:79], v[208:223]
    v_fma_f32 v94, v94, s42, -v36
    v_fma_f32 v95, v95, s42, -v36
    v_exp_f32 v80, v80
    ds_read_b128 v[60:63], v15 offset:0
    buffer_load_dwordx4 v24, s[20:23], s39 offen offset:0  lds
    v_mfma_f32_32x32x16_bf16 v[224:239], v[64:67], v[76:79], v[224:239]
    v_exp_f32 v81, v81
    v_exp_f32 v82, v82
    v_exp_f32 v83, v83
    v_exp_f32 v84, v84
    ds_read_b128 v[64:67], v12 offset:128
    buffer_load_dwordx4 v25, s[20:23], s39 offen offset:1024  lds
    v_mfma_f32_32x32x16_bf16 v[240:255], v[68:71], v[76:79], v[240:255]
    v_exp_f32 v85, v85
    v_exp_f32 v86, v86
    v_exp_f32 v87, v87
    ds_read_b128 v[68:71], v13 offset:128
    buffer_load_dwordx4 v26, s[20:23], s39 offen offset:2048  lds
    s_add_u32 s39, s39, 122880
    s_waitcnt lgkmcnt(5)
    v_mfma_f32_32x32x16_bf16 v[96:111], v[48:51], v[112:115], 0
    ds_read_b128 v[48:51], v14 offset:128
    v_exp_f32 v88, v88
    v_exp_f32 v89, v89
    v_exp_f32 v90, v90
    s_waitcnt lgkmcnt(5)
    v_mfma_f32_32x32x16_bf16 v[96:111], v[52:55], v[116:119], v[96:111]
    ds_read_b128 v[52:55], v15 offset:128
    v_exp_f32 v91, v91
    v_exp_f32 v92, v92
    v_exp_f32 v93, v93
    s_waitcnt lgkmcnt(5)
    v_mfma_f32_32x32x16_bf16 v[96:111], v[56:59], v[120:123], v[96:111]
    ds_read_b128 v[56:59], v12 offset:256
    s_cmp_lg_u32 s75, 0
    s_cbranch_scc1 L_ra9
L_rb9:
    s_nop 0
    v_exp_f32 v94, v94
    v_exp_f32 v95, v95
    s_waitcnt lgkmcnt(5)
    v_mfma_f32_32x32x16_bf16 v[96:111], v[60:63], v[124:127], v[96:111]
    ds_read_b128 v[60:63], v13 offset:256
    v_cvt_pk_bf16_f32 v72, v80, v81
    v_add_f32 v38, v38, v80
    v_add_f32 v39, v39, v81
    s_waitcnt lgkmcnt(5)
    v_mfma_f32_32x32x16_bf16 v[96:111], v[64:67], v[128:131], v[96:111]
    ds_read_b128 v[64:67], v14 offset:256
    v_cvt_pk_bf16_f32 v73, v82, v83
    v_add_f32 v38, v38, v82
    v_add_f32 v39, v39, v83
    s_waitcnt lgkmcnt(5)
    v_mfma_f32_32x32x16_bf16 v[96:111], v[68:71], v[132:135], v[96:111]
    ds_read_b128 v[68:71], v15 offset:256
    v_cvt_pk_bf16_f32 v74, v84, v85
    v_add_f32 v38, v38, v84
    s_waitcnt lgkmcnt(5)
    v_mfma_f32_32x32x16_bf16 v[96:111], v[48:51], v[136:139], v[96:111]
    s_mov_b32 s33, s32
    s_add_u32 s32, s32, 24576
    s_cmp_eq_u32 s32, 122880
    s_cselect_b32 s32, 0, s32
    v_add_f32 v39, v39, v85
    v_cvt_pk_bf16_f32 v75, v86, v87
    v_add_f32 v38, v38, v86
    s_waitcnt lgkmcnt(4)
    v_mfma_f32_32x32x16_bf16 v[96:111], v[52:55], v[140:143], v[96:111]
    v_add_u32 v12, s32, v9
    v_xor_b32 v13, 16, v12
    v_xor_b32 v14, 64, v12
    v_xor_b32 v15, 0x50, v12
    v_add_f32 v39, v39, v87
    v_cvt_pk_bf16_f32 v76, v88, v89
    v_add_f32 v38, v38, v88
    s_waitcnt lgkmcnt(3)
    v_mfma_f32_32x32x16_bf16 v[96:111], v[56:59], v[144:147], v[96:111]
    v_add_f32 v39, v39, v89
    v_cvt_pk_bf16_f32 v77, v90, v91
    s_waitcnt vmcnt(10) lgkmcnt(0)
    s_barrier
    ds_read_b64_tr_b16 v[48:49], v12 offset:0
    ds_read_b64_tr_b16 v[50:51], v13 offset:1536
    ds_read_b64_tr_b16 v[52:53], v14 offset:0
    ds_read_b64_tr_b16 v[54:55], v15 offset:1536
    ds_read_b64_tr_b16 v[56:57], v12 offset:128
    ds_read_b64_tr_b16 v[58:59], v13 offset:1664
    s_add_u32 m0, s33, s34
    s_nop 0
    v_mfma_f32_32x32x16_bf16 v[96:111], v[60:63], v[148:151], v[96:111]
    v_add_f32 v38, v38, v90
    v_add_f32 v39, v39, v91
    v_cvt_pk_bf16_f32 v78, v92, v93
    ds_read_b64_tr_b16 v[60:61], v14 offset:128
    ds_read_b64_tr_b16 v[62:63], v15 offset:1664
    buffer_load_dwordx4 v24, s[20:23], s39 offen offset:0  lds
    v_mfma_f32_32x32x16_bf16 v[96:111], v[64:67], v[152:155], v[96:111]
    v_cvt_pk_bf16_f32 v79, v94, v95
    v_add_f32 v38, v38, v92
    v_add_f32 v39, v39, v93
    ds_read_b64_tr_b16 v[64:65], v12 offset:256
    ds_read_b64_tr_b16 v[66:67], v13 offset:1792
    buffer_load_dwordx4 v25, s[20:23], s39 offen offset:1024  lds
    v_mfma_f32_32x32x16_bf16 v[96:111], v[68:71], v[156:159], v[96:111]
    v_add_f32 v38, v38, v94
    v_add_f32 v39, v39, v95
    ds_read_b64_tr_b16 v[68:69], v14 offset:256
    ds_read_b64_tr_b16 v[70:71], v15 offset:1792
    buffer_load_dwordx4 v26, s[20:23], s39 offen offset:2048  lds
    s_add_u32 s39, s39, 122880
    s_nop 0
    s_waitcnt lgkmcnt(10)
    v_mfma_f32_32x32x16_bf16 v[160:175], v[48:51], v[72:75], v[160:175]
    ds_read_b64_tr_b16 v[48:49], v12 offset:6144
    ds_read_b64_tr_b16 v[50:51], v13 offset:7680
    s_waitcnt lgkmcnt(10)
    v_mfma_f32_32x32x16_bf16 v[176:191], v[52:55], v[72:75], v[176:191]
    ds_read_b64_tr_b16 v[52:53], v14 offset:6144
    ds_read_b64_tr_b16 v[54:55], v15 offset:7680
    s_waitcnt lgkmcnt(10)
    v_mfma_f32_32x32x16_bf16 v[192:207], v[56:59], v[72:75], v[192:207]
    ds_read_b64_tr_b16 v[56:57], v12 offset:6272
    ds_read_b64_tr_b16 v[58:59], v13 offset:7808
    v_max3_f32 v40, v96, v97, v98
    v_max3_f32 v40, v40, v99, v100
    v_max3_f32 v40, v40, v101, v102
    v_max3_f32 v40, v40, v103, v104
    v_max3_f32 v40, v40, v105, v106
    v_max3_f32 v40, v40, v107, v108
    v_max3_f32 v40, v40, v109, v110
    s_waitcnt lgkmcnt(10)
    v_mfma_f32_32x32x16_bf16 v[208:223], v[60:63], v[72:75], v[208:223]
    ds_read_b64_tr_b16 v[60:61], v14 offset:6272
    ds_read_b64_tr_b16 v[62:63], v15 offset:7808
    v_max_f32 v40, v40, v111
    v_mov_b32 v41, v40
    s_nop 1
    v_permlane32_swap_b32 v40, v41
    s_nop 1
    v_max_f32 v40, v40, v41
    v_mul_f32 v40, s42, v40
    v_cmp_gt_f32 vcc, v40, v37
    s_cbranch_vccnz L_ra10
L_rb10:
    s_nop 0
    v_fma_f32 v96, v96, s42, -v36
    v_fma_f32 v97, v97, s42, -v36
    s_waitcnt lgkmcnt(10)
    v_mfma_f32_32x32x16_bf16 v[224:239], v[64:67], v[72:75], v[224:239]
    ds_read_b64_tr_b16 v[64:65], v12 offset:6400
    ds_read_b64_tr_b16 v[66:67], v13 offset:7936
    v_fma_f32 v98, v98, s42, -v36
    v_fma_f32 v99, v99, s42, -v36
    v_fma_f32 v100, v100, s42, -v36
    v_fma_f32 v101, v101, s42, -v36
    v_fma_f32 v102, v102, s42, -v36
    v_fma_f32 v103, v103, s42, -v36
    v_fma_f32 v104, v104, s42, -v36
    s_waitcnt lgkmcnt(10)
    v_mfma_f32_32x32x16_bf16 v[240:255], v[68:71], v[72:75], v[240:255]
    ds_read_b64_tr_b16 v[68:69], v14 offset:6400
    ds_read_b64_tr_b16 v[70:71], v15 offset:7936
    v_fma_f32 v105, v105, s42, -v36
    v_fma_f32 v106, v106, s42, -v36
    v_fma_f32 v107, v107, s42, -v36
    v_fma_f32 v108, v108, s42, -v36
    v_fma_f32 v109, v109, s42, -v36
    v_fma_f32 v110, v110, s42, -v36
    v_fma_f32 v111, v111, s42, -v36
    s_waitcnt lgkmcnt(10)
    v_mfma_f32_32x32x16_bf16 v[160:175], v[48:51], v[76:79], v[160:175]
    s_mov_b32 s33, s32
    s_add_u32 s32, s32, 24576
    s_cmp_eq_u32 s32, 122880
    s_cselect_b32 s32, 0, s32
    v_exp_f32 v96, v96
    v_exp_f32 v97, v97
    v_exp_f32 v98, v98
    v_exp_f32 v99, v99
    v_exp_f32 v100, v100
    v_exp_f32 v101, v101
    s_waitcnt lgkmcnt(8)
    v_mfma_f32_32x32x16_bf16 v[176:191], v[52:55], v[76:79], v[176:191]
    v_add_u32 v12, s32, v9
    v_xor_b32 v13, 16, v12
    v_xor_b32 v14, 64, v12
    v_xor_b32 v15, 0x50, v12
    v_exp_f32 v102, v102
    v_exp_f32 v103, v103
    v_exp_f32 v104, v104
    v_exp_f32 v105, v105
    v_exp_f32 v106, v106
    v_exp_f32 v107, v107
    v_exp_f32 v108, v108
    s_waitcnt lgkmcnt(6)
    v_mfma_f32_32x32x16_bf16 v[192:207], v[56:59], v[76:79], v[192:207]
    v_exp_f32 v109, v109
    v_exp_f32 v110, v110
    v_exp_f32 v111, v111
    v_cvt_pk_bf16_f32 v80, v96, v97
    v_add_f32 v38, v38, v96
    v_add_f32 v39, v39, v97
    v_cvt_pk_bf16_f32 v81, v98, v99
    s_waitcnt vmcnt(10) lgkmcnt(0)
    s_barrier
    ds_read_b64_tr_b16 v[48:49], v12 offset:0
    ds_read_b64_tr_b16 v[50:51], v13 offset:1536
    ds_read_b64_tr_b16 v[52:53], v14 offset:0
    ds_read_b64_tr_b16 v[54:55], v15 offset:1536
    ds_read_b64_tr_b16 v[56:57], v12 offset:128
    ds_read_b64_tr_b16 v[58:59], v13 offset:1664
    s_add_u32 m0, s33, s34
    s_nop 0
    v_mfma_f32_32x32x16_bf16 v[208:223], v[60:63], v[76:79], v[208:223]
    v_add_f32 v38, v38, v98
    v_add_f32 v39, v39, v99
    v_cvt_pk_bf16_f32 v82, v100, v101
    v_add_f32 v38, v38, v100
    v_add_f32 v39, v39, v101
    v_cvt_pk_bf16_f32 v83, v102, v103
    v_add_f32 v38, v38, v102
    ds_read_b64_tr_b16 v[60:61], v14 offset:128
    ds_read_b64_tr_b16 v[62:63], v15 offset:1664
    buffer_load_dwordx4 v24, s[20:23], s39 offen offset:0  lds
    v_mfma_f32_32x32x16_bf16 v[224:239], v[64:67], v[76:79], v[224:239]
    v_add_f32 v39, v39, v103
    v_cvt_pk_bf16_f32 v84, v104, v105
    v_add_f32 v38, v38, v104
    v_add_f32 v39, v39, v105
    v_cvt_pk_bf16_f32 v85, v106, v107
    v_add_f32 v38, v38, v106
    v_add_f32 v39, v39, v107
    ds_read_b64_tr_b16 v[64:65], v12 offset:256
    ds_read_b64_tr_b16 v[66:67], v13 offset:1792
    buffer_load_dwordx4 v25, s[20:23], s39 offen offset:1024  lds
    v_mfma_f32_32x32x16_bf16 v[240:255], v[68:71], v[76:79], v[240:255]
    v_cvt_pk_bf16_f32 v86, v108, v109
    v_cvt_pk_bf16_f32 v87, v110, v111
    v_add_f32 v38, v38, v108
    v_add_f32 v39, v39, v109
    v_add_f32 v38, v38, v110
    v_add_f32 v39, v39, v111
    ds_read_b64_tr_b16 v[68:69], v14 offset:256
    ds_read_b64_tr_b16 v[70:71], v15 offset:1792
    buffer_load_dwordx4 v26, s[20:23], s39 offen offset:2048  lds
    s_sub_u32 s39, s39, 368384
    s_cmp_lg_u32 s75, 0
    s_cbranch_scc1 L_ra11
L_rb11:
    s_nop 0
    s_waitcnt lgkmcnt(10)
    v_mfma_f32_32x32x16_bf16 v[160:175], v[48:51], v[80:83], v[160:175]
    ds_read_b64_tr_b16 v[48:49], v12 offset:6144
    ds_read_b64_tr_b16 v[50:51], v13 offset:7680
    s_waitcnt lgkmcnt(10)
    v_mfma_f32_32x32x16_bf16 v[176:191], v[52:55], v[80:83], v[176:191]
    ds_read_b64_tr_b16 v[52:53], v14 offset:6144
    ds_read_b64_tr_b16 v[54:55], v15 offset:7680
    s_waitcnt lgkmcnt(10)
    v_mfma_f32_32x32x16_bf16 v[192:207], v[56:59], v[80:83], v[192:207]
    ds_read_b64_tr_b16 v[56:57], v12 offset:6272
    ds_read_b64_tr_b16 v[58:59], v13 offset:7808
    s_waitcnt lgkmcnt(10)
    v_mfma_f32_32x32x16_bf16 v[208:223], v[60:63], v[80:83], v[208:223]
    ds_read_b64_tr_b16 v[60:61], v14 offset:6272
    ds_read_b64_tr_b16 v[62:63], v15 offset:7808
    s_waitcnt lgkmcnt(10)
    v_mfma_f32_32x32x16_bf16 v[224:239], v[64:67], v[80:83], v[224:239]
    ds_read_b64_tr_b16 v[64:65], v12 offset:6400
    ds_read_b64_tr_b16 v[66:67], v13 offset:7936
    s_waitcnt lgkmcnt(10)
    v_mfma_f32_32x32x16_bf16 v[240:255], v[68:71], v[80:83], v[240:255]
    ds_read_b64_tr_b16 v[68:69], v14 offset:6400
    ds_read_b64_tr_b16 v[70:71], v15 offset:7936
    s_waitcnt lgkmcnt(10)
    v_mfma_f32_32x32x16_bf16 v[160:175], v[48:51], v[84:87], v[160:175]
    s_mov_b32 s33, s32
    s_add_u32 s32, s32, 24576
    s_cmp_eq_u32 s32, 122880
    s_cselect_b32 s32, 0, s32
    s_waitcnt lgkmcnt(8)
    v_mfma_f32_32x32x16_bf16 v[176:191], v[52:55], v[84:87], v[176:191]
    v_add_u32 v12, s32, v10
    v_xor_b32 v13, 64, v12
    s_waitcnt lgkmcnt(6)
    v_mfma_f32_32x32x16_bf16 v[192:207], v[56:59], v[84:87], v[192:207]
    s_waitcnt vmcnt(9) lgkmcnt(0)
    s_barrier
    ds_read_b64_tr_b16 v[48:49], v12 offset:0
    ds_read_b64_tr_b16 v[50:51], v12 offset:1024
    ds_read_b64_tr_b16 v[52:53], v12 offset:4096
    ds_read_b64_tr_b16 v[54:55], v12 offset:5120
    ds_read_b64_tr_b16 v[56:57], v12 offset:8192
    ds_read_b64_tr_b16 v[58:59], v12 offset:9216
    s_add_u32 m0, s33, s34
    s_nop 0
    v_mfma_f32_32x32x16_bf16 v[208:223], v[60:63], v[84:87], v[208:223]
    ds_read_b64_tr_b16 v[60:61], v12 offset:12288
    ds_read_b64_tr_b16 v[62:63], v12 offset:13312
    buffer_load_dwordx4 v24, s[20:23], s39 offen offset:0  lds
    v_mfma_f32_32x32x16_bf16 v[224:239], v[64:67], v[84:87], v[224:239]
    ds_read_b64_tr_b16 v[64:65], v12 offset:16384
    ds_read_b64_tr_b16 v[66:67], v12 offset:17408
    buffer_load_dwordx4 v25, s[20:23], s39 offen offset:1024  lds
    v_mfma_f32_32x32x16_bf16 v[240:255], v[68:71], v[84:87], v[240:255]
    ds_read_b64_tr_b16 v[68:69], v12 offset:20480
    ds_read_b64_tr_b16 v[70:71], v12 offset:21504
    buffer_load_dwordx4 v26, s[20:23], s39 offen offset:2048  lds
    s_add_u32 s39, s39, 122880
    v_add_f32 v38, v38, v39
    v_mov_b32 v39, v38
    s_nop 1
    v_permlane32_swap_b32 v38, v39
    s_nop 1
    v_add_f32 v38, v38, v39
    v_rcp_f32 v40, v38
    s_nop 7
    v_mov_b32 v41, v40
    v_pk_mul_f32 v[160:161], v[160:161], v[40:41]
    v_pk_mul_f32 v[162:163], v[162:163], v[40:41]
    v_pk_mul_f32 v[164:165], v[164:165], v[40:41]
    v_pk_mul_f32 v[166:167], v[166:167], v[40:41]
    v_pk_mul_f32 v[168:169], v[168:169], v[40:41]
    v_pk_mul_f32 v[170:171], v[170:171], v[40:41]
    v_pk_mul_f32 v[172:173], v[172:173], v[40:41]
    v_pk_mul_f32 v[174:175], v[174:175], v[40:41]
    v_pk_mul_f32 v[176:177], v[176:177], v[40:41]
    v_pk_mul_f32 v[178:179], v[178:179], v[40:41]
    v_pk_mul_f32 v[180:181], v[180:181], v[40:41]
    v_pk_mul_f32 v[182:183], v[182:183], v[40:41]
    v_pk_mul_f32 v[184:185], v[184:185], v[40:41]
    v_pk_mul_f32 v[186:187], v[186:187], v[40:41]
    v_pk_mul_f32 v[188:189], v[188:189], v[40:41]
    v_pk_mul_f32 v[190:191], v[190:191], v[40:41]
    v_cvt_pk_bf16_f32 v112, v160, v161
    v_cvt_pk_bf16_f32 v113, v162, v163
    v_cvt_pk_bf16_f32 v114, v164, v165
    v_cvt_pk_bf16_f32 v115, v166, v167
    v_cvt_pk_bf16_f32 v116, v168, v169
    v_cvt_pk_bf16_f32 v117, v170, v171
    v_cvt_pk_bf16_f32 v118, v172, v173
    v_cvt_pk_bf16_f32 v119, v174, v175
    v_cvt_pk_bf16_f32 v120, v176, v177
    v_cvt_pk_bf16_f32 v121, v178, v179
    v_cvt_pk_bf16_f32 v122, v180, v181
    v_cvt_pk_bf16_f32 v123, v182, v183
    v_cvt_pk_bf16_f32 v124, v184, v185
    v_cvt_pk_bf16_f32 v125, v186, v187
    v_cvt_pk_bf16_f32 v126, v188, v189
    v_cvt_pk_bf16_f32 v127, v190, v191
    ds_write_b128 v44, v[112:115] offset:0
    ds_write_b128 v44, v[116:119] offset:1024
    ds_write_b128 v44, v[120:123] offset:2048
    ds_write_b128 v44, v[124:127] offset:3072
    v_pk_mul_f32 v[192:193], v[192:193], v[40:41]
    v_pk_mul_f32 v[194:195], v[194:195], v[40:41]
    v_pk_mul_f32 v[196:197], v[196:197], v[40:41]
    v_pk_mul_f32 v[198:199], v[198:199], v[40:41]
    v_pk_mul_f32 v[200:201], v[200:201], v[40:41]
    v_pk_mul_f32 v[202:203], v[202:203], v[40:41]
    v_pk_mul_f32 v[204:205], v[204:205], v[40:41]
    v_pk_mul_f32 v[206:207], v[206:207], v[40:41]
    v_pk_mul_f32 v[208:209], v[208:209], v[40:41]
    v_pk_mul_f32 v[210:211], v[210:211], v[40:41]
    v_pk_mul_f32 v[212:213], v[212:213], v[40:41]
    v_pk_mul_f32 v[214:215], v[214:215], v[40:41]
    v_pk_mul_f32 v[216:217], v[216:217], v[40:41]
    v_pk_mul_f32 v[218:219], v[218:219], v[40:41]
    v_pk_mul_f32 v[220:221], v[220:221], v[40:41]
    v_pk_mul_f32 v[222:223], v[222:223], v[40:41]
    v_cvt_pk_bf16_f32 v128, v192, v193
    v_cvt_pk_bf16_f32 v129, v194, v195
    v_cvt_pk_bf16_f32 v130, v196, v197
    v_cvt_pk_bf16_f32 v131, v198, v199
    v_cvt_pk_bf16_f32 v132, v200, v201
    v_cvt_pk_bf16_f32 v133, v202, v203
    v_cvt_pk_bf16_f32 v134, v204, v205
    v_cvt_pk_bf16_f32 v135, v206, v207
    v_cvt_pk_bf16_f32 v136, v208, v209
    v_cvt_pk_bf16_f32 v137, v210, v211
    v_cvt_pk_bf16_f32 v138, v212, v213
    v_cvt_pk_bf16_f32 v139, v214, v215
    v_cvt_pk_bf16_f32 v140, v216, v217
    v_cvt_pk_bf16_f32 v141, v218, v219
    v_cvt_pk_bf16_f32 v142, v220, v221
    v_cvt_pk_bf16_f32 v143, v222, v223
    v_pk_mul_f32 v[224:225], v[224:225], v[40:41]
    v_pk_mul_f32 v[226:227], v[226:227], v[40:41]
    v_pk_mul_f32 v[228:229], v[228:229], v[40:41]
    v_pk_mul_f32 v[230:231], v[230:231], v[40:41]
    v_pk_mul_f32 v[232:233], v[232:233], v[40:41]
    v_pk_mul_f32 v[234:235], v[234:235], v[40:41]
    v_pk_mul_f32 v[236:237], v[236:237], v[40:41]
    v_pk_mul_f32 v[238:239], v[238:239], v[40:41]
    v_pk_mul_f32 v[240:241], v[240:241], v[40:41]
    v_pk_mul_f32 v[242:243], v[242:243], v[40:41]
    v_pk_mul_f32 v[244:245], v[244:245], v[40:41]
    v_pk_mul_f32 v[246:247], v[246:247], v[40:41]
    v_pk_mul_f32 v[248:249], v[248:249], v[40:41]
    v_pk_mul_f32 v[250:251], v[250:251], v[40:41]
    v_pk_mul_f32 v[252:253], v[252:253], v[40:41]
    v_pk_mul_f32 v[254:255], v[254:255], v[40:41]
    v_cvt_pk_bf16_f32 v144, v224, v225
    v_cvt_pk_bf16_f32 v145, v226, v227
    v_cvt_pk_bf16_f32 v146, v228, v229
    v_cvt_pk_bf16_f32 v147, v230, v231
    v_cvt_pk_bf16_f32 v148, v232, v233
    v_cvt_pk_bf16_f32 v149, v234, v235
    v_cvt_pk_bf16_f32 v150, v236, v237
    v_cvt_pk_bf16_f32 v151, v238, v239
    v_cvt_pk_bf16_f32 v152, v240, v241
    v_cvt_pk_bf16_f32 v153, v242, v243
    v_cvt_pk_bf16_f32 v154, v244, v245
    v_cvt_pk_bf16_f32 v155, v246, v247
    v_cvt_pk_bf16_f32 v156, v248, v249
    v_cvt_pk_bf16_f32 v157, v250, v251
    v_cvt_pk_bf16_f32 v158, v252, v253
    v_cvt_pk_bf16_f32 v159, v254, v255
    s_waitcnt lgkmcnt(0)
    s_barrier
    ds_read_b128 v[160:163], v45 offset:0
    ds_read_b128 v[208:211], v45 offset:16384
    ds_read_b128 v[164:167], v45 offset:1024
    ds_read_b128 v[212:215], v45 offset:17408
    ds_read_b128 v[168:171], v45 offset:2048
    ds_read_b128 v[216:219], v45 offset:18432
    ds_read_b128 v[172:175], v45 offset:3072
    ds_read_b128 v[220:223], v45 offset:19456
    s_waitcnt lgkmcnt(0)
    s_barrier
    ds_write_b128 v44, v[128:131] offset:0
    ds_write_b128 v44, v[132:135] offset:1024
    ds_write_b128 v44, v[136:139] offset:2048
    ds_write_b128 v44, v[140:143] offset:3072
    s_waitcnt lgkmcnt(0)
    s_barrier
    ds_read_b128 v[176:179], v45 offset:0
    ds_read_b128 v[224:227], v45 offset:16384
    ds_read_b128 v[180:183], v45 offset:1024
    ds_read_b128 v[228:231], v45 offset:17408
    ds_read_b128 v[184:187], v45 offset:2048
    ds_read_b128 v[232:235], v45 offset:18432
    ds_read_b128 v[188:191], v45 offset:3072
    ds_read_b128 v[236:239], v45 offset:19456
    s_waitcnt lgkmcnt(0)
    s_barrier
    ds_write_b128 v44, v[144:147] offset:0
    ds_write_b128 v44, v[148:151] offset:1024
    ds_write_b128 v44, v[152:155] offset:2048
    ds_write_b128 v44, v[156:159] offset:3072
    s_waitcnt lgkmcnt(0)
    s_barrier
    ds_read_b128 v[192:195], v45 offset:0
    ds_read_b128 v[240:243], v45 offset:16384
    ds_read_b128 v[196:199], v45 offset:1024
    ds_read_b128 v[244:247], v45 offset:17408
    ds_read_b128 v[200:203], v45 offset:2048
    ds_read_b128 v[248:251], v45 offset:18432
    ds_read_b128 v[204:207], v45 offset:3072
    ds_read_b128 v[252:255], v45 offset:19456
    s_waitcnt lgkmcnt(0)
    s_mov_b32 s47, 0x100000
    s_mov_b32 s38, 5
L_o:
    s_waitcnt lgkmcnt(10)
    v_mfma_f32_32x32x16_bf16 v[112:127], v[48:51], v[160:163], 0
    ds_read_b64_tr_b16 v[48:49], v13 offset:0
    ds_read_b64_tr_b16 v[50:51], v13 offset:1024
    s_waitcnt lgkmcnt(10)
    v_mfma_f32_32x32x16_bf16 v[112:127], v[52:55], v[164:167], v[112:127]
    ds_read_b64_tr_b16 v[52:53], v13 offset:4096
    ds_read_b64_tr_b16 v[54:55], v13 offset:5120
    s_waitcnt lgkmcnt(10)
    v_mfma_f32_32x32x16_bf16 v[112:127], v[56:59], v[168:171], v[112:127]
    ds_read_b64_tr_b16 v[56:57], v13 offset:8192
    ds_read_b64_tr_b16 v[58:59], v13 offset:9216
    v_cvt_pk_bf16_f32 v152, v128, v129
    v_cvt_pk_bf16_f32 v153, v130, v131
    v_cvt_pk_bf16_f32 v154, v132, v133
    s_waitcnt lgkmcnt(10)
    v_mfma_f32_32x32x16_bf16 v[112:127], v[60:63], v[172:175], v[112:127]
    ds_read_b64_tr_b16 v[60:61], v13 offset:12288
    ds_read_b64_tr_b16 v[62:63], v13 offset:13312
    v_cvt_pk_bf16_f32 v155, v134, v135
    v_cvt_pk_bf16_f32 v156, v136, v137
    s_waitcnt lgkmcnt(10)
    v_mfma_f32_32x32x16_bf16 v[112:127], v[64:67], v[176:179], v[112:127]
    ds_read_b64_tr_b16 v[64:65], v13 offset:16384
    ds_read_b64_tr_b16 v[66:67], v13 offset:17408
    v_cvt_pk_bf16_f32 v157, v138, v139
    v_cvt_pk_bf16_f32 v158, v140, v141
    v_cvt_pk_bf16_f32 v159, v142, v143
    s_waitcnt lgkmcnt(10)
    v_mfma_f32_32x32x16_bf16 v[112:127], v[68:71], v[180:183], v[112:127]
    ds_read_b64_tr_b16 v[68:69], v13 offset:20480
    ds_read_b64_tr_b16 v[70:71], v13 offset:21504
    buffer_store_dwordx4 v[152:155], v43, s[28:31], s47 offen offset:2048 sc0 sc1
    buffer_store_dwordx4 v[156:159], v43, s[28:31], s47 offen offset:3072 sc0 sc1
    s_waitcnt lgkmcnt(10)
    v_mfma_f32_32x32x16_bf16 v[128:143], v[48:51], v[160:163], 0
    s_mov_b32 s33, s32
    s_add_u32 s32, s32, 24576
    s_cmp_eq_u32 s32, 122880
    s_cselect_b32 s32, 0, s32
    s_waitcnt lgkmcnt(8)
    v_mfma_f32_32x32x16_bf16 v[128:143], v[52:55], v[164:167], v[128:143]
    v_add_u32 v12, s32, v10
    v_xor_b32 v13, 64, v12
    s_waitcnt lgkmcnt(6)
    v_mfma_f32_32x32x16_bf16 v[128:143], v[56:59], v[168:171], v[128:143]
    s_waitcnt vmcnt(11) lgkmcnt(0)
    s_barrier
    ds_read_b64_tr_b16 v[48:49], v12 offset:0
    ds_read_b64_tr_b16 v[50:51], v12 offset:1024
    ds_read_b64_tr_b16 v[52:53], v12 offset:4096
    ds_read_b64_tr_b16 v[54:55], v12 offset:5120
    ds_read_b64_tr_b16 v[56:57], v12 offset:8192
    ds_read_b64_tr_b16 v[58:59], v12 offset:9216
    s_add_u32 m0, s33, s34
    s_nop 0
    v_mfma_f32_32x32x16_bf16 v[128:143], v[60:63], v[172:175], v[128:143]
    ds_read_b64_tr_b16 v[60:61], v12 offset:12288
    ds_read_b64_tr_b16 v[62:63], v12 offset:13312
    buffer_load_dwordx4 v24, s[20:23], s39 offen offset:0  lds
    v_mfma_f32_32x32x16_bf16 v[128:143], v[64:67], v[176:179], v[128:143]
    ds_read_b64_tr_b16 v[64:65], v12 offset:16384
    ds_read_b64_tr_b16 v[66:67], v12 offset:17408
    buffer_load_dwordx4 v25, s[20:23], s39 offen offset:1024  lds
    v_mfma_f32_32x32x16_bf16 v[128:143], v[68:71], v[180:183], v[128:143]
    ds_read_b64_tr_b16 v[68:69], v12 offset:20480
    ds_read_b64_tr_b16 v[70:71], v12 offset:21504
    buffer_load_dwordx4 v26, s[20:23], s39 offen offset:2048  lds
    s_add_u32 s39, s39, 122880
    s_waitcnt lgkmcnt(10)
    v_mfma_f32_32x32x16_bf16 v[112:127], v[48:51], v[184:187], v[112:127]
    ds_read_b64_tr_b16 v[48:49], v13 offset:0
    ds_read_b64_tr_b16 v[50:51], v13 offset:1024
    s_waitcnt lgkmcnt(10)
    v_mfma_f32_32x32x16_bf16 v[112:127], v[52:55], v[188:191], v[112:127]
    ds_read_b64_tr_b16 v[52:53], v13 offset:4096
    ds_read_b64_tr_b16 v[54:55], v13 offset:5120
    s_waitcnt lgkmcnt(10)
    v_mfma_f32_32x32x16_bf16 v[112:127], v[56:59], v[192:195], v[112:127]
    ds_read_b64_tr_b16 v[56:57], v13 offset:8192
    ds_read_b64_tr_b16 v[58:59], v13 offset:9216
    s_waitcnt lgkmcnt(10)
    v_mfma_f32_32x32x16_bf16 v[112:127], v[60:63], v[196:199], v[112:127]
    ds_read_b64_tr_b16 v[60:61], v13 offset:12288
    ds_read_b64_tr_b16 v[62:63], v13 offset:13312
    s_waitcnt lgkmcnt(10)
    v_mfma_f32_32x32x16_bf16 v[112:127], v[64:67], v[200:203], v[112:127]
    ds_read_b64_tr_b16 v[64:65], v13 offset:16384
    ds_read_b64_tr_b16 v[66:67], v13 offset:17408
    s_waitcnt lgkmcnt(10)
    v_mfma_f32_32x32x16_bf16 v[112:127], v[68:71], v[204:207], v[112:127]
    ds_read_b64_tr_b16 v[68:69], v13 offset:20480
    ds_read_b64_tr_b16 v[70:71], v13 offset:21504
    s_waitcnt lgkmcnt(10)
    v_mfma_f32_32x32x16_bf16 v[128:143], v[48:51], v[184:187], v[128:143]
    s_mov_b32 s33, s32
    s_add_u32 s32, s32, 24576
    s_cmp_eq_u32 s32, 122880
    s_cselect_b32 s32, 0, s32
    s_waitcnt lgkmcnt(8)
    v_mfma_f32_32x32x16_bf16 v[128:143], v[52:55], v[188:191], v[128:143]
    v_add_u32 v12, s32, v10
    v_xor_b32 v13, 64, v12
    s_waitcnt lgkmcnt(6)
    v_mfma_f32_32x32x16_bf16 v[128:143], v[56:59], v[192:195], v[128:143]
    s_waitcnt vmcnt(11) lgkmcnt(0)
    s_barrier
    ds_read_b64_tr_b16 v[48:49], v12 offset:0
    ds_read_b64_tr_b16 v[50:51], v12 offset:1024
    ds_read_b64_tr_b16 v[52:53], v12 offset:4096
    ds_read_b64_tr_b16 v[54:55], v12 offset:5120
    ds_read_b64_tr_b16 v[56:57], v12 offset:8192
    ds_read_b64_tr_b16 v[58:59], v12 offset:9216
    s_add_u32 m0, s33, s34
    s_nop 0
    v_mfma_f32_32x32x16_bf16 v[128:143], v[60:63], v[196:199], v[128:143]
    ds_read_b64_tr_b16 v[60:61], v12 offset:12288
    ds_read_b64_tr_b16 v[62:63], v12 offset:13312
    buffer_load_dwordx4 v24, s[20:23], s39 offen offset:0  lds
    v_mfma_f32_32x32x16_bf16 v[128:143], v[64:67], v[200:203], v[128:143]
    ds_read_b64_tr_b16 v[64:65], v12 offset:16384
    ds_read_b64_tr_b16 v[66:67], v12 offset:17408
    buffer_load_dwordx4 v25, s[20:23], s39 offen offset:1024  lds
    v_mfma_f32_32x32x16_bf16 v[128:143], v[68:71], v[204:207], v[128:143]
    ds_read_b64_tr_b16 v[68:69], v12 offset:20480
    ds_read_b64_tr_b16 v[70:71], v12 offset:21504
    buffer_load_dwordx4 v26, s[20:23], s39 offen offset:2048  lds
    s_add_u32 s39, s39, 122880
    s_waitcnt lgkmcnt(10)
    v_mfma_f32_32x32x16_bf16 v[112:127], v[48:51], v[208:211], v[112:127]
    ds_read_b64_tr_b16 v[48:49], v13 offset:0
    ds_read_b64_tr_b16 v[50:51], v13 offset:1024
    s_waitcnt lgkmcnt(10)
    v_mfma_f32_32x32x16_bf16 v[112:127], v[52:55], v[212:215], v[112:127]
    ds_read_b64_tr_b16 v[52:53], v13 offset:4096
    ds_read_b64_tr_b16 v[54:55], v13 offset:5120
    s_waitcnt lgkmcnt(10)
    v_mfma_f32_32x32x16_bf16 v[112:127], v[56:59], v[216:219], v[112:127]
    ds_read_b64_tr_b16 v[56:57], v13 offset:8192
    ds_read_b64_tr_b16 v[58:59], v13 offset:9216
    s_waitcnt lgkmcnt(10)
    v_mfma_f32_32x32x16_bf16 v[112:127], v[60:63], v[220:223], v[112:127]
    ds_read_b64_tr_b16 v[60:61], v13 offset:12288
    ds_read_b64_tr_b16 v[62:63], v13 offset:13312
    s_waitcnt lgkmcnt(10)
    v_mfma_f32_32x32x16_bf16 v[112:127], v[64:67], v[224:227], v[112:127]
    ds_read_b64_tr_b16 v[64:65], v13 offset:16384
    ds_read_b64_tr_b16 v[66:67], v13 offset:17408
    s_waitcnt lgkmcnt(10)
    v_mfma_f32_32x32x16_bf16 v[112:127], v[68:71], v[228:231], v[112:127]
    ds_read_b64_tr_b16 v[68:69], v13 offset:20480
    ds_read_b64_tr_b16 v[70:71], v13 offset:21504
    s_waitcnt lgkmcnt(10)
    v_mfma_f32_32x32x16_bf16 v[128:143], v[48:51], v[208:211], v[128:143]
    s_mov_b32 s33, s32
    s_add_u32 s32, s32, 24576
    s_cmp_eq_u32 s32, 122880
    s_cselect_b32 s32, 0, s32
    s_waitcnt lgkmcnt(8)
    v_mfma_f32_32x32x16_bf16 v[128:143], v[52:55], v[212:215], v[128:143]
    v_add_u32 v12, s32, v10
    v_xor_b32 v13, 64, v12
    s_waitcnt lgkmcnt(6)
    v_mfma_f32_32x32x16_bf16 v[128:143], v[56:59], v[216:219], v[128:143]
    s_waitcnt vmcnt(11) lgkmcnt(0)
    s_barrier
    ds_read_b64_tr_b16 v[48:49], v12 offset:0
    ds_read_b64_tr_b16 v[50:51], v12 offset:1024
    ds_read_b64_tr_b16 v[52:53], v12 offset:4096
    ds_read_b64_tr_b16 v[54:55], v12 offset:5120
    ds_read_b64_tr_b16 v[56:57], v12 offset:8192
    ds_read_b64_tr_b16 v[58:59], v12 offset:9216
    s_add_u32 m0, s33, s34
    s_nop 0
    v_mfma_f32_32x32x16_bf16 v[128:143], v[60:63], v[220:223], v[128:143]
    ds_read_b64_tr_b16 v[60:61], v12 offset:12288
    ds_read_b64_tr_b16 v[62:63], v12 offset:13312
    buffer_load_dwordx4 v24, s[20:23], s39 offen offset:0  lds
    v_mfma_f32_32x32x16_bf16 v[128:143], v[64:67], v[224:227], v[128:143]
    ds_read_b64_tr_b16 v[64:65], v12 offset:16384
    ds_read_b64_tr_b16 v[66:67], v12 offset:17408
    buffer_load_dwordx4 v25, s[20:23], s39 offen offset:1024  lds
    v_mfma_f32_32x32x16_bf16 v[128:143], v[68:71], v[228:231], v[128:143]
    ds_read_b64_tr_b16 v[68:69], v12 offset:20480
    ds_read_b64_tr_b16 v[70:71], v12 offset:21504
    buffer_load_dwordx4 v26, s[20:23], s39 offen offset:2048  lds
    s_sub_u32 s39, s39, 368384
    s_waitcnt lgkmcnt(10)
    v_mfma_f32_32x32x16_bf16 v[112:127], v[48:51], v[232:235], v[112:127]
    ds_read_b64_tr_b16 v[48:49], v13 offset:0
    ds_read_b64_tr_b16 v[50:51], v13 offset:1024
    s_waitcnt lgkmcnt(10)
    v_mfma_f32_32x32x16_bf16 v[112:127], v[52:55], v[236:239], v[112:127]
    ds_read_b64_tr_b16 v[52:53], v13 offset:4096
    ds_read_b64_tr_b16 v[54:55], v13 offset:5120
    s_waitcnt lgkmcnt(10)
    v_mfma_f32_32x32x16_bf16 v[112:127], v[56:59], v[240:243], v[112:127]
    ds_read_b64_tr_b16 v[56:57], v13 offset:8192
    ds_read_b64_tr_b16 v[58:59], v13 offset:9216
    s_waitcnt lgkmcnt(10)
    v_mfma_f32_32x32x16_bf16 v[112:127], v[60:63], v[244:247], v[112:127]
    ds_read_b64_tr_b16 v[60:61], v13 offset:12288
    ds_read_b64_tr_b16 v[62:63], v13 offset:13312
    s_waitcnt lgkmcnt(10)
    v_mfma_f32_32x32x16_bf16 v[112:127], v[64:67], v[248:251], v[112:127]
    ds_read_b64_tr_b16 v[64:65], v13 offset:16384
    ds_read_b64_tr_b16 v[66:67], v13 offset:17408
    s_waitcnt lgkmcnt(10)
    v_mfma_f32_32x32x16_bf16 v[112:127], v[68:71], v[252:255], v[112:127]
    ds_read_b64_tr_b16 v[68:69], v13 offset:20480
    ds_read_b64_tr_b16 v[70:71], v13 offset:21504
    s_waitcnt lgkmcnt(10)
    v_mfma_f32_32x32x16_bf16 v[128:143], v[48:51], v[232:235], v[128:143]
    s_mov_b32 s33, s32
    s_add_u32 s32, s32, 24576
    s_cmp_eq_u32 s32, 122880
    s_cselect_b32 s32, 0, s32
    s_waitcnt lgkmcnt(8)
    v_mfma_f32_32x32x16_bf16 v[128:143], v[52:55], v[236:239], v[128:143]
    v_add_u32 v12, s32, v10
    v_xor_b32 v13, 64, v12
    s_waitcnt lgkmcnt(6)
    v_mfma_f32_32x32x16_bf16 v[128:143], v[56:59], v[240:243], v[128:143]
    v_cvt_pk_bf16_f32 v144, v112, v113
    v_cvt_pk_bf16_f32 v145, v114, v115
    v_cvt_pk_bf16_f32 v146, v116, v117
    v_cvt_pk_bf16_f32 v147, v118, v119
    s_waitcnt vmcnt(11) lgkmcnt(0)
    s_barrier
    ds_read_b64_tr_b16 v[48:49], v12 offset:0
    ds_read_b64_tr_b16 v[50:51], v12 offset:1024
    ds_read_b64_tr_b16 v[52:53], v12 offset:4096
    ds_read_b64_tr_b16 v[54:55], v12 offset:5120
    ds_read_b64_tr_b16 v[56:57], v12 offset:8192
    ds_read_b64_tr_b16 v[58:59], v12 offset:9216
    s_cmp_le_u32 s38, 2
    s_cselect_b32 s22, 0, s22
    s_add_u32 m0, s33, s34
    s_nop 0
    v_mfma_f32_32x32x16_bf16 v[128:143], v[60:63], v[244:247], v[128:143]
    v_cvt_pk_bf16_f32 v148, v120, v121
    v_cvt_pk_bf16_f32 v149, v122, v123
    v_cvt_pk_bf16_f32 v150, v124, v125
    v_cvt_pk_bf16_f32 v151, v126, v127
    ds_read_b64_tr_b16 v[60:61], v12 offset:12288
    ds_read_b64_tr_b16 v[62:63], v12 offset:13312
    buffer_load_dwordx4 v24, s[20:23], s39 offen offset:0  lds
    buffer_load_dwordx4 v25, s[20:23], s39 offen offset:1024  lds
    v_mfma_f32_32x32x16_bf16 v[128:143], v[64:67], v[248:251], v[128:143]
    ds_read_b64_tr_b16 v[64:65], v12 offset:16384
    ds_read_b64_tr_b16 v[66:67], v12 offset:17408
    buffer_load_dwordx4 v26, s[20:23], s39 offen offset:2048  lds
    s_add_u32 s39, s39, 122880
    buffer_store_dwordx4 v[144:147], v43, s[28:31], s46 offen offset:0 sc0 sc1
    v_mfma_f32_32x32x16_bf16 v[128:143], v[68:71], v[252:255], v[128:143]
    ds_read_b64_tr_b16 v[68:69], v12 offset:20480
    ds_read_b64_tr_b16 v[70:71], v12 offset:21504
    buffer_store_dwordx4 v[148:151], v43, s[28:31], s46 offen offset:1024 sc0 sc1
    s_mov_b32 s47, s46
    s_add_u32 s46, s46, 8192
    s_sub_u32 s38, s38, 1
    s_cmp_lg_u32 s38, 0
    s_cbranch_scc1 L_o
    s_nop 15
    v_cvt_pk_bf16_f32 v152, v128, v129
    v_cvt_pk_bf16_f32 v153, v130, v131
    v_cvt_pk_bf16_f32 v154, v132, v133
    v_cvt_pk_bf16_f32 v155, v134, v135
    v_cvt_pk_bf16_f32 v156, v136, v137
    v_cvt_pk_bf16_f32 v157, v138, v139
    v_cvt_pk_bf16_f32 v158, v140, v141
    v_cvt_pk_bf16_f32 v159, v142, v143
    buffer_store_dwordx4 v[152:155], v43, s[28:31], s47 offen offset:2048 sc0 sc1
    buffer_store_dwordx4 v[156:159], v43, s[28:31], s47 offen offset:3072 sc0 sc1
L_end:
    s_endpgm
L_ra1:
    v_max_f32 v40, v40, v36
    v_sub_f32 v42, v36, v40
    v_exp_f32 v42, v42
    v_mov_b32 v36, v40
    v_add_f32 v37, s44, v40
    v_mul_f32 v38, v38, v42
    v_mul_f32 v39, v39, v42
    s_branch L_rb1
L_ra2:
    v_max_f32 v40, v40, v36
    v_sub_f32 v42, v36, v40
    v_exp_f32 v42, v42
    v_mov_b32 v36, v40
    v_add_f32 v37, s44, v40
    v_mul_f32 v38, v38, v42
    v_mul_f32 v39, v39, v42
    s_mov_b32 s75, 1
    s_branch L_rb2
L_ra3:
    s_nop 15
    v_mul_f32 v160, v160, v42
    v_mul_f32 v161, v161, v42
    v_mul_f32 v162, v162, v42
    v_mul_f32 v163, v163, v42
    v_mul_f32 v164, v164, v42
    v_mul_f32 v165, v165, v42
    v_mul_f32 v166, v166, v42
    v_mul_f32 v167, v167, v42
    v_mul_f32 v168, v168, v42
    v_mul_f32 v169, v169, v42
    v_mul_f32 v170, v170, v42
    v_mul_f32 v171, v171, v42
    v_mul_f32 v172, v172, v42
    v_mul_f32 v173, v173, v42
    v_mul_f32 v174, v174, v42
    v_mul_f32 v175, v175, v42
    v_mul_f32 v176, v176, v42
    v_mul_f32 v177, v177, v42
    v_mul_f32 v178, v178, v42
    v_mul_f32 v179, v179, v42
    v_mul_f32 v180, v180, v42
    v_mul_f32 v181, v181, v42
    v_mul_f32 v182, v182, v42
    v_mul_f32 v183, v183, v42
    v_mul_f32 v184, v184, v42
    v_mul_f32 v185, v185, v42
    v_mul_f32 v186, v186, v42
    v_mul_f32 v187, v187, v42
    v_mul_f32 v188, v188, v42
    v_mul_f32 v189, v189, v42
    v_mul_f32 v190, v190, v42
    v_mul_f32 v191, v191, v42
    v_mul_f32 v192, v192, v42
    v_mul_f32 v193, v193, v42
    v_mul_f32 v194, v194, v42
    v_mul_f32 v195, v195, v42
    v_mul_f32 v196, v196, v42
    v_mul_f32 v197, v197, v42
    v_mul_f32 v198, v198, v42
    v_mul_f32 v199, v199, v42
    v_mul_f32 v200, v200, v42
    v_mul_f32 v201, v201, v42
    v_mul_f32 v202, v202, v42
    v_mul_f32 v203, v203, v42
    v_mul_f32 v204, v204, v42
    v_mul_f32 v205, v205, v42
    v_mul_f32 v206, v206, v42
    v_mul_f32 v207, v207, v42
    v_mul_f32 v208, v208, v42
    v_mul_f32 v209, v209, v42
    v_mul_f32 v210, v210, v42
    v_mul_f32 v211, v211, v42
    v_mul_f32 v212, v212, v42
    v_mul_f32 v213, v213, v42
    v_mul_f32 v214, v214, v42
    v_mul_f32 v215, v215, v42
    v_mul_f32 v216, v216, v42
    v_mul_f32 v217, v217, v42
    v_mul_f32 v218, v218, v42
    v_mul_f32 v219, v219, v42
    v_mul_f32 v220, v220, v42
    v_mul_f32 v221, v221, v42
    v_mul_f32 v222, v222, v42
    v_mul_f32 v223, v223, v42
    v_mul_f32 v224, v224, v42
    v_mul_f32 v225, v225, v42
    v_mul_f32 v226, v226, v42
    v_mul_f32 v227, v227, v42
    v_mul_f32 v228, v228, v42
    v_mul_f32 v229, v229, v42
    v_mul_f32 v230, v230, v42
    v_mul_f32 v231, v231, v42
    v_mul_f32 v232, v232, v42
    v_mul_f32 v233, v233, v42
    v_mul_f32 v234, v234, v42
    v_mul_f32 v235, v235, v42
    v_mul_f32 v236, v236, v42
    v_mul_f32 v237, v237, v42
    v_mul_f32 v238, v238, v42
    v_mul_f32 v239, v239, v42
    v_mul_f32 v240, v240, v42
    v_mul_f32 v241, v241, v42
    v_mul_f32 v242, v242, v42
    v_mul_f32 v243, v243, v42
    v_mul_f32 v244, v244, v42
    v_mul_f32 v245, v245, v42
    v_mul_f32 v246, v246, v42
    v_mul_f32 v247, v247, v42
    v_mul_f32 v248, v248, v42
    v_mul_f32 v249, v249, v42
    v_mul_f32 v250, v250, v42
    v_mul_f32 v251, v251, v42
    v_mul_f32 v252, v252, v42
    v_mul_f32 v253, v253, v42
    v_mul_f32 v254, v254, v42
    v_mul_f32 v255, v255, v42
    s_mov_b32 s75, 0
    s_nop 1
    s_branch L_rb3
L_ra4:
    v_max_f32 v40, v40, v36
    v_sub_f32 v42, v36, v40
    v_exp_f32 v42, v42
    v_mov_b32 v36, v40
    v_add_f32 v37, s44, v40
    v_mul_f32 v38, v38, v42
    v_mul_f32 v39, v39, v42
    s_mov_b32 s75, 1
    s_branch L_rb4
L_ra5:
    s_nop 15
    v_mul_f32 v160, v160, v42
    v_mul_f32 v161, v161, v42
    v_mul_f32 v162, v162, v42
    v_mul_f32 v163, v163, v42
    v_mul_f32 v164, v164, v42
    v_mul_f32 v165, v165, v42
    v_mul_f32 v166, v166, v42
    v_mul_f32 v167, v167, v42
    v_mul_f32 v168, v168, v42
    v_mul_f32 v169, v169, v42
    v_mul_f32 v170, v170, v42
    v_mul_f32 v171, v171, v42
    v_mul_f32 v172, v172, v42
    v_mul_f32 v173, v173, v42
    v_mul_f32 v174, v174, v42
    v_mul_f32 v175, v175, v42
    v_mul_f32 v176, v176, v42
    v_mul_f32 v177, v177, v42
    v_mul_f32 v178, v178, v42
    v_mul_f32 v179, v179, v42
    v_mul_f32 v180, v180, v42
    v_mul_f32 v181, v181, v42
    v_mul_f32 v182, v182, v42
    v_mul_f32 v183, v183, v42
    v_mul_f32 v184, v184, v42
    v_mul_f32 v185, v185, v42
    v_mul_f32 v186, v186, v42
    v_mul_f32 v187, v187, v42
    v_mul_f32 v188, v188, v42
    v_mul_f32 v189, v189, v42
    v_mul_f32 v190, v190, v42
    v_mul_f32 v191, v191, v42
    v_mul_f32 v192, v192, v42
    v_mul_f32 v193, v193, v42
    v_mul_f32 v194, v194, v42
    v_mul_f32 v195, v195, v42
    v_mul_f32 v196, v196, v42
    v_mul_f32 v197, v197, v42
    v_mul_f32 v198, v198, v42
    v_mul_f32 v199, v199, v42
    v_mul_f32 v200, v200, v42
    v_mul_f32 v201, v201, v42
    v_mul_f32 v202, v202, v42
    v_mul_f32 v203, v203, v42
    v_mul_f32 v204, v204, v42
    v_mul_f32 v205, v205, v42
    v_mul_f32 v206, v206, v42
    v_mul_f32 v207, v207, v42
    v_mul_f32 v208, v208, v42
    v_mul_f32 v209, v209, v42
    v_mul_f32 v210, v210, v42
    v_mul_f32 v211, v211, v42
    v_mul_f32 v212, v212, v42
    v_mul_f32 v213, v213, v42
    v_mul_f32 v214, v214, v42
    v_mul_f32 v215, v215, v42
    v_mul_f32 v216, v216, v42
    v_mul_f32 v217, v217, v42
    v_mul_f32 v218, v218, v42
    v_mul_f32 v219, v219, v42
    v_mul_f32 v220, v220, v42
    v_mul_f32 v221, v221, v42
    v_mul_f32 v222, v222, v42
    v_mul_f32 v223, v223, v42
    v_mul_f32 v224, v224, v42
    v_mul_f32 v225, v225, v42
    v_mul_f32 v226, v226, v42
    v_mul_f32 v227, v227, v42
    v_mul_f32 v228, v228, v42
    v_mul_f32 v229, v229, v42
    v_mul_f32 v230, v230, v42
    v_mul_f32 v231, v231, v42
    v_mul_f32 v232, v232, v42
    v_mul_f32 v233, v233, v42
    v_mul_f32 v234, v234, v42
    v_mul_f32 v235, v235, v42
    v_mul_f32 v236, v236, v42
    v_mul_f32 v237, v237, v42
    v_mul_f32 v238, v238, v42
    v_mul_f32 v239, v239, v42
    v_mul_f32 v240, v240, v42
    v_mul_f32 v241, v241, v42
    v_mul_f32 v242, v242, v42
    v_mul_f32 v243, v243, v42
    v_mul_f32 v244, v244, v42
    v_mul_f32 v245, v245, v42
    v_mul_f32 v246, v246, v42
    v_mul_f32 v247, v247, v42
    v_mul_f32 v248, v248, v42
    v_mul_f32 v249, v249, v42
    v_mul_f32 v250, v250, v42
    v_mul_f32 v251, v251, v42
    v_mul_f32 v252, v252, v42
    v_mul_f32 v253, v253, v42
    v_mul_f32 v254, v254, v42
    v_mul_f32 v255, v255, v42
    s_mov_b32 s75, 0
    s_nop 1
    s_branch L_rb5
L_ra6:
    v_max_f32 v40, v40, v36
    v_sub_f32 v42, v36, v40
    v_exp_f32 v42, v42
    v_mov_b32 v36, v40
    v_add_f32 v37, s44, v40
    v_mul_f32 v38, v38, v42
    v_mul_f32 v39, v39, v42
    s_mov_b32 s75, 1
    s_branch L_rb6
L_ra7:
    s_nop 15
    v_mul_f32 v160, v160, v42
    v_mul_f32 v161, v161, v42
    v_mul_f32 v162, v162, v42
    v_mul_f32 v163, v163, v42
    v_mul_f32 v164, v164, v42
    v_mul_f32 v165, v165, v42
    v_mul_f32 v166, v166, v42
    v_mul_f32 v167, v167, v42
    v_mul_f32 v168, v168, v42
    v_mul_f32 v169, v169, v42
    v_mul_f32 v170, v170, v42
    v_mul_f32 v171, v171, v42
    v_mul_f32 v172, v172, v42
    v_mul_f32 v173, v173, v42
    v_mul_f32 v174, v174, v42
    v_mul_f32 v175, v175, v42
    v_mul_f32 v176, v176, v42
    v_mul_f32 v177, v177, v42
    v_mul_f32 v178, v178, v42
    v_mul_f32 v179, v179, v42
    v_mul_f32 v180, v180, v42
    v_mul_f32 v181, v181, v42
    v_mul_f32 v182, v182, v42
    v_mul_f32 v183, v183, v42
    v_mul_f32 v184, v184, v42
    v_mul_f32 v185, v185, v42
    v_mul_f32 v186, v186, v42
    v_mul_f32 v187, v187, v42
    v_mul_f32 v188, v188, v42
    v_mul_f32 v189, v189, v42
    v_mul_f32 v190, v190, v42
    v_mul_f32 v191, v191, v42
    v_mul_f32 v192, v192, v42
    v_mul_f32 v193, v193, v42
    v_mul_f32 v194, v194, v42
    v_mul_f32 v195, v195, v42
    v_mul_f32 v196, v196, v42
    v_mul_f32 v197, v197, v42
    v_mul_f32 v198, v198, v42
    v_mul_f32 v199, v199, v42
    v_mul_f32 v200, v200, v42
    v_mul_f32 v201, v201, v42
    v_mul_f32 v202, v202, v42
    v_mul_f32 v203, v203, v42
    v_mul_f32 v204, v204, v42
    v_mul_f32 v205, v205, v42
    v_mul_f32 v206, v206, v42
    v_mul_f32 v207, v207, v42
    v_mul_f32 v208, v208, v42
    v_mul_f32 v209, v209, v42
    v_mul_f32 v210, v210, v42
    v_mul_f32 v211, v211, v42
    v_mul_f32 v212, v212, v42
    v_mul_f32 v213, v213, v42
    v_mul_f32 v214, v214, v42
    v_mul_f32 v215, v215, v42
    v_mul_f32 v216, v216, v42
    v_mul_f32 v217, v217, v42
    v_mul_f32 v218, v218, v42
    v_mul_f32 v219, v219, v42
    v_mul_f32 v220, v220, v42
    v_mul_f32 v221, v221, v42
    v_mul_f32 v222, v222, v42
    v_mul_f32 v223, v223, v42
    v_mul_f32 v224, v224, v42
    v_mul_f32 v225, v225, v42
    v_mul_f32 v226, v226, v42
    v_mul_f32 v227, v227, v42
    v_mul_f32 v228, v228, v42
    v_mul_f32 v229, v229, v42
    v_mul_f32 v230, v230, v42
    v_mul_f32 v231, v231, v42
    v_mul_f32 v232, v232, v42
    v_mul_f32 v233, v233, v42
    v_mul_f32 v234, v234, v42
    v_mul_f32 v235, v235, v42
    v_mul_f32 v236, v236, v42
    v_mul_f32 v237, v237, v42
    v_mul_f32 v238, v238, v42
    v_mul_f32 v239, v239, v42
    v_mul_f32 v240, v240, v42
    v_mul_f32 v241, v241, v42
    v_mul_f32 v242, v242, v42
    v_mul_f32 v243, v243, v42
    v_mul_f32 v244, v244, v42
    v_mul_f32 v245, v245, v42
    v_mul_f32 v246, v246, v42
    v_mul_f32 v247, v247, v42
    v_mul_f32 v248, v248, v42
    v_mul_f32 v249, v249, v42
    v_mul_f32 v250, v250, v42
    v_mul_f32 v251, v251, v42
    v_mul_f32 v252, v252, v42
    v_mul_f32 v253, v253, v42
    v_mul_f32 v254, v254, v42
    v_mul_f32 v255, v255, v42
    s_mov_b32 s75, 0
    s_nop 1
    s_branch L_rb7
L_ra8:
    v_max_f32 v40, v40, v36
    v_sub_f32 v42, v36, v40
    v_exp_f32 v42, v42
    v_mov_b32 v36, v40
    v_add_f32 v37, s44, v40
    v_mul_f32 v38, v38, v42
    v_mul_f32 v39, v39, v42
    s_mov_b32 s75, 1
    s_branch L_rb8
L_ra9:
    s_nop 15
    v_mul_f32 v160, v160, v42
    v_mul_f32 v161, v161, v42
    v_mul_f32 v162, v162, v42
    v_mul_f32 v163, v163, v42
    v_mul_f32 v164, v164, v42
    v_mul_f32 v165, v165, v42
    v_mul_f32 v166, v166, v42
    v_mul_f32 v167, v167, v42
    v_mul_f32 v168, v168, v42
    v_mul_f32 v169, v169, v42
    v_mul_f32 v170, v170, v42
    v_mul_f32 v171, v171, v42
    v_mul_f32 v172, v172, v42
    v_mul_f32 v173, v173, v42
    v_mul_f32 v174, v174, v42
    v_mul_f32 v175, v175, v42
    v_mul_f32 v176, v176, v42
    v_mul_f32 v177, v177, v42
    v_mul_f32 v178, v178, v42
    v_mul_f32 v179, v179, v42
    v_mul_f32 v180, v180, v42
    v_mul_f32 v181, v181, v42
    v_mul_f32 v182, v182, v42
    v_mul_f32 v183, v183, v42
    v_mul_f32 v184, v184, v42
    v_mul_f32 v185, v185, v42
    v_mul_f32 v186, v186, v42
    v_mul_f32 v187, v187, v42
    v_mul_f32 v188, v188, v42
    v_mul_f32 v189, v189, v42
    v_mul_f32 v190, v190, v42
    v_mul_f32 v191, v191, v42
    v_mul_f32 v192, v192, v42
    v_mul_f32 v193, v193, v42
    v_mul_f32 v194, v194, v42
    v_mul_f32 v195, v195, v42
    v_mul_f32 v196, v196, v42
    v_mul_f32 v197, v197, v42
    v_mul_f32 v198, v198, v42
    v_mul_f32 v199, v199, v42
    v_mul_f32 v200, v200, v42
    v_mul_f32 v201, v201, v42
    v_mul_f32 v202, v202, v42
    v_mul_f32 v203, v203, v42
    v_mul_f32 v204, v204, v42
    v_mul_f32 v205, v205, v42
    v_mul_f32 v206, v206, v42
    v_mul_f32 v207, v207, v42
    v_mul_f32 v208, v208, v42
    v_mul_f32 v209, v209, v42
    v_mul_f32 v210, v210, v42
    v_mul_f32 v211, v211, v42
    v_mul_f32 v212, v212, v42
    v_mul_f32 v213, v213, v42
    v_mul_f32 v214, v214, v42
    v_mul_f32 v215, v215, v42
    v_mul_f32 v216, v216, v42
    v_mul_f32 v217, v217, v42
    v_mul_f32 v218, v218, v42
    v_mul_f32 v219, v219, v42
    v_mul_f32 v220, v220, v42
    v_mul_f32 v221, v221, v42
    v_mul_f32 v222, v222, v42
    v_mul_f32 v223, v223, v42
    v_mul_f32 v224, v224, v42
    v_mul_f32 v225, v225, v42
    v_mul_f32 v226, v226, v42
    v_mul_f32 v227, v227, v42
    v_mul_f32 v228, v228, v42
    v_mul_f32 v229, v229, v42
    v_mul_f32 v230, v230, v42
    v_mul_f32 v231, v231, v42
    v_mul_f32 v232, v232, v42
    v_mul_f32 v233, v233, v42
    v_mul_f32 v234, v234, v42
    v_mul_f32 v235, v235, v42
    v_mul_f32 v236, v236, v42
    v_mul_f32 v237, v237, v42
    v_mul_f32 v238, v238, v42
    v_mul_f32 v239, v239, v42
    v_mul_f32 v240, v240, v42
    v_mul_f32 v241, v241, v42
    v_mul_f32 v242, v242, v42
    v_mul_f32 v243, v243, v42
    v_mul_f32 v244, v244, v42
    v_mul_f32 v245, v245, v42
    v_mul_f32 v246, v246, v42
    v_mul_f32 v247, v247, v42
    v_mul_f32 v248, v248, v42
    v_mul_f32 v249, v249, v42
    v_mul_f32 v250, v250, v42
    v_mul_f32 v251, v251, v42
    v_mul_f32 v252, v252, v42
    v_mul_f32 v253, v253, v42
    v_mul_f32 v254, v254, v42
    v_mul_f32 v255, v255, v42
    s_mov_b32 s75, 0
    s_nop 1
    s_branch L_rb9
L_ra10:
    v_max_f32 v40, v40, v36
    v_sub_f32 v42, v36, v40
    v_exp_f32 v42, v42
    v_mov_b32 v36, v40
    v_add_f32 v37, s44, v40
    v_mul_f32 v38, v38, v42
    v_mul_f32 v39, v39, v42
    s_mov_b32 s75, 1
    s_branch L_rb10
L_ra11:
    s_nop 15
    v_mul_f32 v160, v160, v42
    v_mul_f32 v161, v161, v42
    v_mul_f32 v162, v162, v42
    v_mul_f32 v163, v163, v42
    v_mul_f32 v164, v164, v42
    v_mul_f32 v165, v165, v42
    v_mul_f32 v166, v166, v42
    v_mul_f32 v167, v167, v42
    v_mul_f32 v168, v168, v42
    v_mul_f32 v169, v169, v42
    v_mul_f32 v170, v170, v42
    v_mul_f32 v171, v171, v42
    v_mul_f32 v172, v172, v42
    v_mul_f32 v173, v173, v42
    v_mul_f32 v174, v174, v42
    v_mul_f32 v175, v175, v42
    v_mul_f32 v176, v176, v42
    v_mul_f32 v177, v177, v42
    v_mul_f32 v178, v178, v42
    v_mul_f32 v179, v179, v42
    v_mul_f32 v180, v180, v42
    v_mul_f32 v181, v181, v42
    v_mul_f32 v182, v182, v42
    v_mul_f32 v183, v183, v42
    v_mul_f32 v184, v184, v42
    v_mul_f32 v185, v185, v42
    v_mul_f32 v186, v186, v42
    v_mul_f32 v187, v187, v42
    v_mul_f32 v188, v188, v42
    v_mul_f32 v189, v189, v42
    v_mul_f32 v190, v190, v42
    v_mul_f32 v191, v191, v42
    v_mul_f32 v192, v192, v42
    v_mul_f32 v193, v193, v42
    v_mul_f32 v194, v194, v42
    v_mul_f32 v195, v195, v42
    v_mul_f32 v196, v196, v42
    v_mul_f32 v197, v197, v42
    v_mul_f32 v198, v198, v42
    v_mul_f32 v199, v199, v42
    v_mul_f32 v200, v200, v42
    v_mul_f32 v201, v201, v42
    v_mul_f32 v202, v202, v42
    v_mul_f32 v203, v203, v42
    v_mul_f32 v204, v204, v42
    v_mul_f32 v205, v205, v42
    v_mul_f32 v206, v206, v42
    v_mul_f32 v207, v207, v42
    v_mul_f32 v208, v208, v42
    v_mul_f32 v209, v209, v42
    v_mul_f32 v210, v210, v42
    v_mul_f32 v211, v211, v42
    v_mul_f32 v212, v212, v42
    v_mul_f32 v213, v213, v42
    v_mul_f32 v214, v214, v42
    v_mul_f32 v215, v215, v42
    v_mul_f32 v216, v216, v42
    v_mul_f32 v217, v217, v42
    v_mul_f32 v218, v218, v42
    v_mul_f32 v219, v219, v42
    v_mul_f32 v220, v220, v42
    v_mul_f32 v221, v221, v42
    v_mul_f32 v222, v222, v42
    v_mul_f32 v223, v223, v42
    v_mul_f32 v224, v224, v42
    v_mul_f32 v225, v225, v42
    v_mul_f32 v226, v226, v42
    v_mul_f32 v227, v227, v42
    v_mul_f32 v228, v228, v42
    v_mul_f32 v229, v229, v42
    v_mul_f32 v230, v230, v42
    v_mul_f32 v231, v231, v42
    v_mul_f32 v232, v232, v42
    v_mul_f32 v233, v233, v42
    v_mul_f32 v234, v234, v42
    v_mul_f32 v235, v235, v42
    v_mul_f32 v236, v236, v42
    v_mul_f32 v237, v237, v42
    v_mul_f32 v238, v238, v42
    v_mul_f32 v239, v239, v42
    v_mul_f32 v240, v240, v42
    v_mul_f32 v241, v241, v42
    v_mul_f32 v242, v242, v42
    v_mul_f32 v243, v243, v42
    v_mul_f32 v244, v244, v42
    v_mul_f32 v245, v245, v42
    v_mul_f32 v246, v246, v42
    v_mul_f32 v247, v247, v42
    v_mul_f32 v248, v248, v42
    v_mul_f32 v249, v249, v42
    v_mul_f32 v250, v250, v42
    v_mul_f32 v251, v251, v42
    v_mul_f32 v252, v252, v42
    v_mul_f32 v253, v253, v42
    v_mul_f32 v254, v254, v42
    v_mul_f32 v255, v255, v42
    s_mov_b32 s75, 0
    s_nop 1
    s_branch L_rb11
.globl reduce_kernel
.p2align 8
.type reduce_kernel,@function
reduce_kernel:
    s_cmp_ge_u32 s2, 256
    s_cbranch_scc1 L_end2
    s_load_dwordx2 s[4:5], s[0:1], 80
    s_load_dwordx2 s[6:7], s[0:1], 96
    s_mul_i32 s16, s2, 65536
    s_lshr_b32 s16, s16, 20
    s_mul_i32 s17, s16, 16
    s_sub_u32 s17, s2, s17
    v_lshrrev_b32 v1, 6, v0
    s_nop 0
    v_readfirstlane_b32 s18, v1
    s_mul_i32 s17, s17, 10
    s_nop 1
    s_add_u32 s17, s17, s18
    v_and_b32 v2, 63, v0
    v_lshlrev_b32 v3, 4, v2
    s_mul_i32 s19, s16, 2621440
    s_lshl_b32 s20, s17, 10
    s_add_u32 s19, s19, s20
    s_waitcnt lgkmcnt(0)
    s_add_u32 s8, s6, s19
    s_addc_u32 s9, s7, 0
    s_and_b32 s9, s9, 0xffff
    s_mov_b32 s10, 2458624
    s_mov_b32 s11, 0x20000
    s_mov_b32 s21, 0
    buffer_load_dwordx4 v[16:19], v3, s[8:11], s21 offen
    s_add_u32 s21, s21, 163840
    buffer_load_dwordx4 v[20:23], v3, s[8:11], s21 offen
    s_add_u32 s21, s21, 163840
    buffer_load_dwordx4 v[24:27], v3, s[8:11], s21 offen
    s_add_u32 s21, s21, 163840
    buffer_load_dwordx4 v[28:31], v3, s[8:11], s21 offen
    s_add_u32 s21, s21, 163840
    buffer_load_dwordx4 v[32:35], v3, s[8:11], s21 offen
    s_add_u32 s21, s21, 163840
    buffer_load_dwordx4 v[36:39], v3, s[8:11], s21 offen
    s_add_u32 s21, s21, 163840
    buffer_load_dwordx4 v[40:43], v3, s[8:11], s21 offen
    s_add_u32 s21, s21, 163840
    buffer_load_dwordx4 v[44:47], v3, s[8:11], s21 offen
    s_add_u32 s21, s21, 163840
    buffer_load_dwordx4 v[48:51], v3, s[8:11], s21 offen
    s_add_u32 s21, s21, 163840
    buffer_load_dwordx4 v[52:55], v3, s[8:11], s21 offen
    s_add_u32 s21, s21, 163840
    buffer_load_dwordx4 v[56:59], v3, s[8:11], s21 offen
    s_add_u32 s21, s21, 163840
    buffer_load_dwordx4 v[60:63], v3, s[8:11], s21 offen
    s_add_u32 s21, s21, 163840
    buffer_load_dwordx4 v[64:67], v3, s[8:11], s21 offen
    s_add_u32 s21, s21, 163840
    buffer_load_dwordx4 v[68:71], v3, s[8:11], s21 offen
    s_add_u32 s21, s21, 163840
    buffer_load_dwordx4 v[72:75], v3, s[8:11], s21 offen
    s_add_u32 s21, s21, 163840
    buffer_load_dwordx4 v[76:79], v3, s[8:11], s21 offen
    s_mov_b32 s12, s4
    s_and_b32 s13, s5, 0xffff
    s_mov_b32 s14, 2621440
    s_mov_b32 s15, 0x20000
    s_mul_i32 s22, s17, 1639
    s_lshr_b32 s22, s22, 16
    s_mul_i32 s23, s22, 40
    s_sub_u32 s23, s17, s23
    s_and_b32 s24, s16, 7
    s_lshl_b32 s24, s24, 2
    s_add_u32 s24, s24, s22
    s_mul_i32 s24, s24, 81920
    s_lshr_b32 s25, s16, 3
    s_mul_i32 s25, s25, 1280
    s_add_u32 s24, s24, s25
    s_lshl_b32 s23, s23, 5
    s_add_u32 s24, s24, s23
    v_and_b32 v4, 31, v2
    v_mul_u32_u24 v4, 2560, v4
    v_lshrrev_b32 v5, 5, v2
    v_lshl_add_u32 v4, v5, 4, v4
    s_mov_b32 s26, 0xffff0000
    s_waitcnt vmcnt(15)
    v_lshlrev_b32 v8, 16, v16
    v_and_b32 v9, s26, v16
    v_lshlrev_b32 v10, 16, v17
    v_and_b32 v11, s26, v17
    v_lshlrev_b32 v12, 16, v18
    v_and_b32 v13, s26, v18
    v_lshlrev_b32 v14, 16, v19
    v_and_b32 v15, s26, v19
    s_waitcnt vmcnt(14)
    v_lshlrev_b32 v80, 16, v20
    v_and_b32 v81, s26, v20
    v_lshlrev_b32 v82, 16, v21
    v_and_b32 v83, s26, v21
    v_lshlrev_b32 v84, 16, v22
    v_and_b32 v85, s26, v22
    v_lshlrev_b32 v86, 16, v23
    v_and_b32 v87, s26, v23
    v_pk_add_f32 v[8:9], v[8:9], v[80:81]
    v_pk_add_f32 v[10:11], v[10:11], v[82:83]
    v_pk_add_f32 v[12:13], v[12:13], v[84:85]
    v_pk_add_f32 v[14:15], v[14:15], v[86:87]
    s_waitcnt vmcnt(13)
    v_lshlrev_b32 v80, 16, v24
    v_and_b32 v81, s26, v24
    v_lshlrev_b32 v82, 16, v25
    v_and_b32 v83, s26, v25
    v_lshlrev_b32 v84, 16, v26
    v_and_b32 v85, s26, v26
    v_lshlrev_b32 v86, 16, v27
    v_and_b32 v87, s26, v27
    v_pk_add_f32 v[8:9], v[8:9], v[80:81]
    v_pk_add_f32 v[10:11], v[10:11], v[82:83]
    v_pk_add_f32 v[12:13], v[12:13], v[84:85]
    v_pk_add_f32 v[14:15], v[14:15], v[86:87]
    s_waitcnt vmcnt(12)
    v_lshlrev_b32 v80, 16, v28
    v_and_b32 v81, s26, v28
    v_lshlrev_b32 v82, 16, v29
    v_and_b32 v83, s26, v29
    v_lshlrev_b32 v84, 16, v30
    v_and_b32 v85, s26, v30
    v_lshlrev_b32 v86, 16, v31
    v_and_b32 v87, s26, v31
    v_pk_add_f32 v[8:9], v[8:9], v[80:81]
    v_pk_add_f32 v[10:11], v[10:11], v[82:83]
    v_pk_add_f32 v[12:13], v[12:13], v[84:85]
    v_pk_add_f32 v[14:15], v[14:15], v[86:87]
    s_waitcnt vmcnt(11)
    v_lshlrev_b32 v80, 16, v32
    v_and_b32 v81, s26, v32
    v_lshlrev_b32 v82, 16, v33
    v_and_b32 v83, s26, v33
    v_lshlrev_b32 v84, 16, v34
    v_and_b32 v85, s26, v34
    v_lshlrev_b32 v86, 16, v35
    v_and_b32 v87, s26, v35
    v_pk_add_f32 v[8:9], v[8:9], v[80:81]
    v_pk_add_f32 v[10:11], v[10:11], v[82:83]
    v_pk_add_f32 v[12:13], v[12:13], v[84:85]
    v_pk_add_f32 v[14:15], v[14:15], v[86:87]
    s_waitcnt vmcnt(10)
    v_lshlrev_b32 v80, 16, v36
    v_and_b32 v81, s26, v36
    v_lshlrev_b32 v82, 16, v37
    v_and_b32 v83, s26, v37
    v_lshlrev_b32 v84, 16, v38
    v_and_b32 v85, s26, v38
    v_lshlrev_b32 v86, 16, v39
    v_and_b32 v87, s26, v39
    v_pk_add_f32 v[8:9], v[8:9], v[80:81]
    v_pk_add_f32 v[10:11], v[10:11], v[82:83]
    v_pk_add_f32 v[12:13], v[12:13], v[84:85]
    v_pk_add_f32 v[14:15], v[14:15], v[86:87]
    s_waitcnt vmcnt(9)
    v_lshlrev_b32 v80, 16, v40
    v_and_b32 v81, s26, v40
    v_lshlrev_b32 v82, 16, v41
    v_and_b32 v83, s26, v41
    v_lshlrev_b32 v84, 16, v42
    v_and_b32 v85, s26, v42
    v_lshlrev_b32 v86, 16, v43
    v_and_b32 v87, s26, v43
    v_pk_add_f32 v[8:9], v[8:9], v[80:81]
    v_pk_add_f32 v[10:11], v[10:11], v[82:83]
    v_pk_add_f32 v[12:13], v[12:13], v[84:85]
    v_pk_add_f32 v[14:15], v[14:15], v[86:87]
    s_waitcnt vmcnt(8)
    v_lshlrev_b32 v80, 16, v44
    v_and_b32 v81, s26, v44
    v_lshlrev_b32 v82, 16, v45
    v_and_b32 v83, s26, v45
    v_lshlrev_b32 v84, 16, v46
    v_and_b32 v85, s26, v46
    v_lshlrev_b32 v86, 16, v47
    v_and_b32 v87, s26, v47
    v_pk_add_f32 v[8:9], v[8:9], v[80:81]
    v_pk_add_f32 v[10:11], v[10:11], v[82:83]
    v_pk_add_f32 v[12:13], v[12:13], v[84:85]
    v_pk_add_f32 v[14:15], v[14:15], v[86:87]
    s_waitcnt vmcnt(7)
    v_lshlrev_b32 v80, 16, v48
    v_and_b32 v81, s26, v48
    v_lshlrev_b32 v82, 16, v49
    v_and_b32 v83, s26, v49
    v_lshlrev_b32 v84, 16, v50
    v_and_b32 v85, s26, v50
    v_lshlrev_b32 v86, 16, v51
    v_and_b32 v87, s26, v51
    v_pk_add_f32 v[8:9], v[8:9], v[80:81]
    v_pk_add_f32 v[10:11], v[10:11], v[82:83]
    v_pk_add_f32 v[12:13], v[12:13], v[84:85]
    v_pk_add_f32 v[14:15], v[14:15], v[86:87]
    s_waitcnt vmcnt(6)
    v_lshlrev_b32 v80, 16, v52
    v_and_b32 v81, s26, v52
    v_lshlrev_b32 v82, 16, v53
    v_and_b32 v83, s26, v53
    v_lshlrev_b32 v84, 16, v54
    v_and_b32 v85, s26, v54
    v_lshlrev_b32 v86, 16, v55
    v_and_b32 v87, s26, v55
    v_pk_add_f32 v[8:9], v[8:9], v[80:81]
    v_pk_add_f32 v[10:11], v[10:11], v[82:83]
    v_pk_add_f32 v[12:13], v[12:13], v[84:85]
    v_pk_add_f32 v[14:15], v[14:15], v[86:87]
    s_waitcnt vmcnt(5)
    v_lshlrev_b32 v80, 16, v56
    v_and_b32 v81, s26, v56
    v_lshlrev_b32 v82, 16, v57
    v_and_b32 v83, s26, v57
    v_lshlrev_b32 v84, 16, v58
    v_and_b32 v85, s26, v58
    v_lshlrev_b32 v86, 16, v59
    v_and_b32 v87, s26, v59
    v_pk_add_f32 v[8:9], v[8:9], v[80:81]
    v_pk_add_f32 v[10:11], v[10:11], v[82:83]
    v_pk_add_f32 v[12:13], v[12:13], v[84:85]
    v_pk_add_f32 v[14:15], v[14:15], v[86:87]
    s_waitcnt vmcnt(4)
    v_lshlrev_b32 v80, 16, v60
    v_and_b32 v81, s26, v60
    v_lshlrev_b32 v82, 16, v61
    v_and_b32 v83, s26, v61
    v_lshlrev_b32 v84, 16, v62
    v_and_b32 v85, s26, v62
    v_lshlrev_b32 v86, 16, v63
    v_and_b32 v87, s26, v63
    v_pk_add_f32 v[8:9], v[8:9], v[80:81]
    v_pk_add_f32 v[10:11], v[10:11], v[82:83]
    v_pk_add_f32 v[12:13], v[12:13], v[84:85]
    v_pk_add_f32 v[14:15], v[14:15], v[86:87]
    s_waitcnt vmcnt(3)
    v_lshlrev_b32 v80, 16, v64
    v_and_b32 v81, s26, v64
    v_lshlrev_b32 v82, 16, v65
    v_and_b32 v83, s26, v65
    v_lshlrev_b32 v84, 16, v66
    v_and_b32 v85, s26, v66
    v_lshlrev_b32 v86, 16, v67
    v_and_b32 v87, s26, v67
    v_pk_add_f32 v[8:9], v[8:9], v[80:81]
    v_pk_add_f32 v[10:11], v[10:11], v[82:83]
    v_pk_add_f32 v[12:13], v[12:13], v[84:85]
    v_pk_add_f32 v[14:15], v[14:15], v[86:87]
    s_waitcnt vmcnt(2)
    v_lshlrev_b32 v80, 16, v68
    v_and_b32 v81, s26, v68
    v_lshlrev_b32 v82, 16, v69
    v_and_b32 v83, s26, v69
    v_lshlrev_b32 v84, 16, v70
    v_and_b32 v85, s26, v70
    v_lshlrev_b32 v86, 16, v71
    v_and_b32 v87, s26, v71
    v_pk_add_f32 v[8:9], v[8:9], v[80:81]
    v_pk_add_f32 v[10:11], v[10:11], v[82:83]
    v_pk_add_f32 v[12:13], v[12:13], v[84:85]
    v_pk_add_f32 v[14:15], v[14:15], v[86:87]
    s_waitcnt vmcnt(1)
    v_lshlrev_b32 v80, 16, v72
    v_and_b32 v81, s26, v72
    v_lshlrev_b32 v82, 16, v73
    v_and_b32 v83, s26, v73
    v_lshlrev_b32 v84, 16, v74
    v_and_b32 v85, s26, v74
    v_lshlrev_b32 v86, 16, v75
    v_and_b32 v87, s26, v75
    v_pk_add_f32 v[8:9], v[8:9], v[80:81]
    v_pk_add_f32 v[10:11], v[10:11], v[82:83]
    v_pk_add_f32 v[12:13], v[12:13], v[84:85]
    v_pk_add_f32 v[14:15], v[14:15], v[86:87]
    s_waitcnt vmcnt(0)
    v_lshlrev_b32 v80, 16, v76
    v_and_b32 v81, s26, v76
    v_lshlrev_b32 v82, 16, v77
    v_and_b32 v83, s26, v77
    v_lshlrev_b32 v84, 16, v78
    v_and_b32 v85, s26, v78
    v_lshlrev_b32 v86, 16, v79
    v_and_b32 v87, s26, v79
    v_pk_add_f32 v[8:9], v[8:9], v[80:81]
    v_pk_add_f32 v[10:11], v[10:11], v[82:83]
    v_pk_add_f32 v[12:13], v[12:13], v[84:85]
    v_pk_add_f32 v[14:15], v[14:15], v[86:87]
    v_cvt_pk_bf16_f32 v16, v8, v9
    v_cvt_pk_bf16_f32 v17, v10, v11
    v_cvt_pk_bf16_f32 v18, v12, v13
    v_cvt_pk_bf16_f32 v19, v14, v15
    buffer_store_dwordx4 v[16:19], v4, s[12:15], s24 offen
L_end2:
    s_endpgm
.section .rodata,"a"
.p2align 6
.amdhsa_kernel attn_kernel
  .amdhsa_next_free_vgpr 256
  .amdhsa_next_free_sgpr 100
  .amdhsa_accum_offset 256
  .amdhsa_group_segment_fixed_size 0
  .amdhsa_kernarg_size 104
  .amdhsa_user_sgpr_count 2
  .amdhsa_user_sgpr_kernarg_segment_ptr 1
  .amdhsa_system_sgpr_workgroup_id_x 1
.end_amdhsa_kernel
.p2align 6
.amdhsa_kernel reduce_kernel
  .amdhsa_next_free_vgpr 88
  .amdhsa_next_free_sgpr 32
  .amdhsa_accum_offset 88
  .amdhsa_group_segment_fixed_size 0
  .amdhsa_kernarg_size 104
  .amdhsa_user_sgpr_count 2
  .amdhsa_user_sgpr_kernarg_segment_ptr 1
  .amdhsa_system_sgpr_workgroup_id_x 1
.end_amdhsa_kernel
```
